```python
import torch

def _softmax(x, axis=-1):
    return torch.softmax(x, dim=axis)
def _gelu(x):
    return torch.nn.functional.gelu(x, approximate="tanh")
def _silu(x):
    return torch.nn.functional.silu(x)
def _sigmoid(x):
    return torch.sigmoid(x)
def _layernorm(x, axis=-1, eps=1e-5):
    m = x.mean(dim=axis, keepdim=True)
    v = x.var(dim=axis, keepdim=True, unbiased=False)
    return (x - m) / torch.sqrt(v + eps)
def _scatter_add(tgt, idx, src, axis=0):
    return tgt.clone().index_add_(axis, idx, src)
def _segment_sum(src, seg, n):
    out = torch.zeros((n,) + src.shape[1:], dtype=src.dtype)
    return out.index_add_(0, seg, src)
def _pad(x, pw):
    flat = tuple(v for pair in reversed(pw) for v in pair)
    return torch.nn.functional.pad(x, flat)

kernel_name = 'interleave_layers__softmax_full_mha__glu_gated_reglu__prompt'

def setup_inputs():

    _w = (lambda a: (lambda t: t.to(torch.bfloat16) if t.is_floating_point() else t)(torch.as_tensor(a)))
    def _A_setup():
        B, S, D = 1, 2048, 512
        return {
            "x": _w((lambda *s: torch.randn(*s, dtype=torch.bfloat16) * 0.05)(B, S, D)),
            "wqkv": _w((lambda *s: torch.randn(*s, dtype=torch.bfloat16) * 0.05)(D, 3 * D)),
            "wo": _w((lambda *s: torch.randn(*s, dtype=torch.bfloat16) * 0.05)(D, D)),
        }
    _A_in = _A_setup()

    def _B_setup():
        B, S, D, F = 1, 2048, 512, 1792
        return {
            "x": _w((lambda *s: torch.randn(*s, dtype=torch.bfloat16) * 0.05)(B, S, D)),
            "W_gate": _w((lambda *s: torch.randn(*s, dtype=torch.bfloat16) * 0.4)(D, F) * (2.0 / D) ** 0.5),
            "W_up": _w((lambda *s: torch.randn(*s, dtype=torch.bfloat16) * 0.4)(D, F) * (2.0 / D) ** 0.5),
            "W_down": _w((lambda *s: torch.randn(*s, dtype=torch.bfloat16) * 0.4)(F, D) * (1.0 / F) ** 0.5),
        }
    _B_in = _B_setup()

    return {
        "A_x": _A_in["x"],
        "A_wqkv": _A_in["wqkv"],
        "A_wo": _A_in["wo"],
        "B_x": _B_in["x"],
        "B_W_gate": _B_in["W_gate"],
        "B_W_up": _B_in["W_up"],
        "B_W_down": _B_in["W_down"],
    }

def reference(A_x, A_wqkv, A_wo, B_x, B_W_gate, B_W_up, B_W_down):
    def _A_ref(x, wqkv, wo):
        B, S, D = x.shape
        H = 32; Dh = D // H
        qkv = (lambda x, *d: x.permute(*d))((x @ wqkv).reshape(B, S, 3, H, Dh), 2, 0, 3, 1, 4)
        q, k, v = qkv[0], qkv[1], qkv[2]
        scale = Dh ** -0.5
        scores = torch.einsum("bhqd,bhkd->bhqk", q, k) * scale
        p = _softmax(scores, axis=-1)
        o = torch.einsum("bhqk,bhkd->bhqd", p, v)
        return (lambda x, *d: x.permute(*d))(o, 0, 2, 1, 3).reshape(B, S, D) @ wo

    def _B_ref(x, W_gate, W_up, W_down):
        gate = torch.einsum("bsd,df->bsf", x, W_gate)
        up = torch.einsum("bsd,df->bsf", x, W_up)
        gate = gate * (lambda x, dt: x.to(dt))(gate > 0, gate.dtype)
        h = gate * up
        return torch.einsum("bsf,fd->bsd", h, W_down)

    x = A_x
    x = x + _A_ref(_layernorm(x, axis=-1), A_wqkv, A_wo)
    x = x + _B_ref(_layernorm(x, axis=-1), B_W_gate, B_W_up, B_W_down)
    x = x + _A_ref(_layernorm(x, axis=-1), A_wqkv, A_wo)
    x = x + _B_ref(_layernorm(x, axis=-1), B_W_gate, B_W_up, B_W_down)
    return x
```

```asm
; @launch kernel=qkv1_kernel grid=(256,1,1) block=(256,1,1) lds=141312
; @launch kernel=attn1_kernel grid=(256,1,1) block=(1024,1,1) lds=163840
; @launch kernel=blk1_kernel grid=(256,1,1) block=(256,1,1) lds=158720
; @launch kernel=attn2_kernel grid=(256,1,1) block=(1024,1,1) lds=163840
; @launch kernel=blk2_kernel grid=(256,1,1) block=(256,1,1) lds=158720
.amdgcn_target "amdgcn-amd-amdhsa--gfx950"
.text
.globl qkv1_kernel
.p2align 8
.type qkv1_kernel,@function
qkv1_kernel:
    s_cmp_ge_u32 s2, 256
    s_cbranch_scc1 qkv1_kernel_end_real
    s_load_dwordx4 s[4:7], s[0:1], 0
    s_load_dwordx2 s[8:9], s[0:1], 72
    v_and_b32 v108, 63, v0
    v_lshrrev_b32 v124, 6, v0
    s_and_b32 s34, s2, 7
    s_lshr_b32 s35, s2, 3
    v_readfirstlane_b32 s26, v124
    v_lshlrev_b32 v109, 4, v108
    s_and_b32 s24, s34, 3
    s_lshl_b32 s24, s24, 3
    s_and_b32 s36, s35, 7
    s_add_u32 s24, s24, s36
    s_lshr_b32 s25, s34, 2
    s_lshl_b32 s25, s25, 2
    s_lshr_b32 s36, s35, 3
    s_add_u32 s25, s25, s36
    v_lshrrev_b32 v124, 3, v108
    v_and_b32 v125, 7, v108
    v_lshrrev_b32 v126, 4, v108
    v_xor_b32 v127, v125, v126
    v_lshlrev_b32 v128, 10, v124
    v_lshl_add_u32 v110, v127, 4, v128
    v_xor_b32 v127, 4, v127
    v_lshl_add_u32 v111, v127, 4, v128
    v_and_b32 v126, 1, v126
    v_lshlrev_b32 v126, 2, v126
    v_xor_b32 v127, v125, v126
    v_mul_u32_u24 v128, 3072, v124
    v_lshl_add_u32 v112, v127, 4, v128
    s_lshl_b32 s29, s24, 16
    s_lshl_b32 s36, s26, 14
    s_add_u32 s29, s29, s36
    s_add_u32 s30, s29, 7168
    s_mul_i32 s31, s26, 49152
    s_lshl_b32 s36, s25, 7
    s_add_u32 s31, s31, s36
    s_add_u32 s32, s31, 23552
    s_lshl_b32 s33, s26, 11
    s_mov_b32 s14, 2097152
    s_mov_b32 s15, 0x00020000
    s_mov_b32 s18, 1572864
    s_mov_b32 s19, 0x00020000
    s_waitcnt lgkmcnt(0)
    s_mov_b32 s12, s4
    s_and_b32 s13, s5, 0xffff
    s_mov_b32 s16, s6
    s_and_b32 s17, s7, 0xffff
    s_add_u32 m0, s33, 0
    s_nop 0
    buffer_load_dwordx4 v110, s[12:15], s29 offen lds
    buffer_load_dwordx4 v111, s[12:15], s30 offen offset:1024 lds
    s_add_u32 s29, s29, 128
    s_add_u32 s30, s30, 128
    s_add_u32 m0, s33, 8192
    s_add_u32 s47, s31, 0
    buffer_load_dwordx4 v112, s[16:19], s47 offen lds
    s_add_u32 s47, s32, 0
    buffer_load_dwordx4 v112, s[16:19], s47 offen offset:1024 lds
    s_add_u32 m0, s33, 16384
    s_add_u32 s47, s31, 1024
    buffer_load_dwordx4 v112, s[16:19], s47 offen lds
    s_add_u32 s47, s32, 1024
    buffer_load_dwordx4 v112, s[16:19], s47 offen offset:1024 lds
    s_add_u32 m0, s33, 24576
    s_add_u32 s47, s31, 2048
    buffer_load_dwordx4 v112, s[16:19], s47 offen lds
    s_add_u32 s47, s32, 2048
    buffer_load_dwordx4 v112, s[16:19], s47 offen offset:1024 lds
    s_add_u32 s31, s31, 196608
    s_add_u32 s32, s32, 196608
    v_lshrrev_b32 v132, 2, v108
    v_lshlrev_b32 v132, 7, v132
    s_lshl_b32 s38, s2, 13
    s_lshl_b32 s40, s26, 11
    s_add_u32 s38, s38, s40
    s_mul_i32 s39, s2, 6144
    s_mul_i32 s40, s26, 1536
    s_add_u32 s39, s39, s40
    buffer_load_dword v144, v132, s[12:15], s38 offen
    buffer_load_dword v145, v132, s[16:19], s39 offen
    s_add_u32 m0, s33, 32768
    s_nop 0
    buffer_load_dwordx4 v110, s[12:15], s29 offen lds
    buffer_load_dwordx4 v111, s[12:15], s30 offen offset:1024 lds
    s_add_u32 s29, s29, 128
    s_add_u32 s30, s30, 128
    s_add_u32 m0, s33, 40960
    s_add_u32 s47, s31, 0
    buffer_load_dwordx4 v112, s[16:19], s47 offen lds
    s_add_u32 s47, s32, 0
    buffer_load_dwordx4 v112, s[16:19], s47 offen offset:1024 lds
    s_add_u32 m0, s33, 49152
    s_add_u32 s47, s31, 1024
    buffer_load_dwordx4 v112, s[16:19], s47 offen lds
    s_add_u32 s47, s32, 1024
    buffer_load_dwordx4 v112, s[16:19], s47 offen offset:1024 lds
    s_and_b32 s36, s26, 1
    s_lshr_b32 s37, s26, 1
    s_lshl_b32 s27, s24, 1
    s_add_u32 s27, s27, s36
    s_lshl_b32 s28, s25, 1
    s_add_u32 s28, s28, s37
    s_mov_b32 s46, 0x3f803f80
    s_mov_b32 s48, s36
    s_mov_b32 s49, s37
    s_mov_b32 s20, s8
    s_and_b32 s21, s9, 0xffff
    s_mov_b32 s22, 41943040
    s_mov_b32 s23, 0x00020000
    v_and_b32 v124, 31, v108
    v_lshrrev_b32 v125, 5, v108
    v_bfe_u32 v126, v108, 1, 3
    v_xor_b32 v126, v126, v125
    v_lshlrev_b32 v127, 7, v124
    s_lshl_b32 s38, s36, 12
    v_add_u32 v127, s38, v127
    s_lshl_b32 s38, s26, 1
    v_xor_b32 v126, s38, v126
    v_xor_b32 v128, 0, v126
    v_lshl_add_u32 v113, v128, 4, v127
    v_add_u32 v117, 65536, v113
    v_xor_b32 v128, 2, v126
    v_lshl_add_u32 v114, v128, 4, v127
    v_add_u32 v118, 65536, v114
    v_xor_b32 v128, 4, v126
    v_lshl_add_u32 v115, v128, 4, v127
    v_add_u32 v119, 65536, v115
    v_xor_b32 v128, 6, v126
    v_lshl_add_u32 v116, v128, 4, v127
    v_add_u32 v120, 65536, v116
    v_lshlrev_b32 v128, 3, v125
    v_bfe_u32 v129, v108, 2, 2
    v_add_u32 v128, v128, v129
    v_lshlrev_b32 v128, 7, v128
    v_bfe_u32 v129, v108, 4, 1
    v_lshlrev_b32 v129, 5, v129
    v_and_b32 v130, 3, v108
    v_lshlrev_b32 v130, 3, v130
    v_bfe_u32 v131, v108, 3, 1
    v_lshlrev_b32 v131, 6, v131
    s_lshl_b32 s38, s37, 6
    v_xor_b32 v131, s38, v131
    v_add3_u32 v128, v128, v129, v130
    v_add3_u32 v128, v128, v131, 0
    s_xor_b32 s38, s26, 0
    s_lshl_b32 s38, s38, 11
    s_add_u32 s38, s38, 8192
    v_add_u32 v240, s38, v128
    v_add_u32 v244, 65536, v240
    s_xor_b32 s38, s26, 1
    s_lshl_b32 s38, s38, 11
    s_add_u32 s38, s38, 8192
    v_add_u32 v241, s38, v128
    v_add_u32 v245, 65536, v241
    s_xor_b32 s38, s26, 2
    s_lshl_b32 s38, s38, 11
    s_add_u32 s38, s38, 8192
    v_add_u32 v242, s38, v128
    v_add_u32 v246, 65536, v242
    s_xor_b32 s38, s26, 3
    s_lshl_b32 s38, s38, 11
    s_add_u32 s38, s38, 8192
    v_add_u32 v243, s38, v128
    v_add_u32 v247, 65536, v243
    v_mov_b32 v96, 0
    v_mov_b32 v100, 0
    v_mov_b32 v97, 0
    v_mov_b32 v101, 0
    v_mov_b32 v98, 0
    v_mov_b32 v102, 0
    v_mov_b32 v99, 0
    v_mov_b32 v103, 0
    v_mov_b32 v104, 0
    v_mov_b32 v105, 0
    v_mov_b32 v106, 0
    v_mov_b32 v107, 0
    v_mov_b32 v250, 0
    v_mov_b32 v251, 0
    v_mov_b32 v252, 0
    s_mov_b32 s50, 0xffff0000
    s_waitcnt vmcnt(8)
    s_barrier
    ds_read_b128 v[84:87], v113 offset:0
    ds_read_b64_tr_b16 v[48:49], v240 offset:0
    ds_read_b64_tr_b16 v[50:51], v240 offset:512
    ds_read_b64_tr_b16 v[52:53], v240 offset:8192
    ds_read_b64_tr_b16 v[54:55], v240 offset:8704
    ds_read_b64_tr_b16 v[56:57], v240 offset:16384
    ds_read_b64_tr_b16 v[58:59], v240 offset:16896
    ds_read_b128 v[88:91], v114 offset:0
    ds_read_b64_tr_b16 v[60:61], v241 offset:0
    ds_read_b64_tr_b16 v[62:63], v241 offset:512
    ds_read_b64_tr_b16 v[64:65], v241 offset:8192
    ds_read_b64_tr_b16 v[66:67], v241 offset:8704
    ds_read_b64_tr_b16 v[68:69], v241 offset:16384
    ds_read_b64_tr_b16 v[70:71], v241 offset:16896
    s_waitcnt lgkmcnt(7)
    v_mfma_f32_32x32x16_bf16 v[0:15], v[48:51], v[84:87], 0
    s_add_u32 m0, s33, 57344
    s_add_u32 s47, s31, 2048
    buffer_load_dwordx4 v112, s[16:19], s47 offen lds
    v_mfma_f32_32x32x16_bf16 v[16:31], v[52:55], v[84:87], 0
    s_add_u32 s47, s32, 2048
    buffer_load_dwordx4 v112, s[16:19], s47 offen offset:1024 lds
    s_add_u32 s31, s31, 196608
    s_add_u32 s32, s32, 196608
    v_mfma_f32_32x32x16_bf16 v[32:47], v[84:87], v[56:59], 0
    s_add_u32 m0, s33, 65536
    s_nop 0
    buffer_load_dwordx4 v110, s[12:15], s29 offen lds
    v_dot2c_f32_bf16 v96, s46, v84
    v_dot2c_f32_bf16 v100, v84, v84
    v_dot2c_f32_bf16 v97, s46, v85
    v_dot2c_f32_bf16 v101, v85, v85
    v_dot2c_f32_bf16 v98, s46, v86
    v_dot2c_f32_bf16 v102, v86, v86
    v_dot2c_f32_bf16 v99, s46, v87
    v_dot2c_f32_bf16 v103, v87, v87
    v_dot2c_f32_bf16 v104, s46, v48
    v_dot2c_f32_bf16 v105, s46, v52
    v_dot2c_f32_bf16 v106, s46, v56
    v_dot2c_f32_bf16 v104, s46, v49
    v_dot2c_f32_bf16 v105, s46, v53
    v_dot2c_f32_bf16 v106, s46, v57
    v_dot2c_f32_bf16 v104, s46, v50
    v_dot2c_f32_bf16 v105, s46, v54
    v_dot2c_f32_bf16 v106, s46, v58
    v_dot2c_f32_bf16 v104, s46, v51
    v_dot2c_f32_bf16 v105, s46, v55
    v_dot2c_f32_bf16 v106, s46, v59
    ds_read_b128 v[92:95], v115 offset:0
    ds_read_b64_tr_b16 v[72:73], v242 offset:0
    ds_read_b64_tr_b16 v[74:75], v242 offset:512
    ds_read_b64_tr_b16 v[76:77], v242 offset:8192
    ds_read_b64_tr_b16 v[78:79], v242 offset:8704
    ds_read_b64_tr_b16 v[80:81], v242 offset:16384
    ds_read_b64_tr_b16 v[82:83], v242 offset:16896
    s_waitcnt lgkmcnt(7)
    v_mfma_f32_32x32x16_bf16 v[0:15], v[60:63], v[88:91], v[0:15]
    buffer_load_dwordx4 v111, s[12:15], s30 offen offset:1024 lds
    s_add_u32 s29, s29, 128
    s_add_u32 s30, s30, 128
    v_mfma_f32_32x32x16_bf16 v[16:31], v[64:67], v[88:91], v[16:31]
    s_add_u32 m0, s33, 73728
    s_add_u32 s47, s31, 0
    buffer_load_dwordx4 v112, s[16:19], s47 offen lds
    v_mfma_f32_32x32x16_bf16 v[32:47], v[88:91], v[68:71], v[32:47]
    s_add_u32 s47, s32, 0
    buffer_load_dwordx4 v112, s[16:19], s47 offen offset:1024 lds
    v_dot2c_f32_bf16 v96, s46, v88
    v_dot2c_f32_bf16 v100, v88, v88
    v_dot2c_f32_bf16 v97, s46, v89
    v_dot2c_f32_bf16 v101, v89, v89
    v_dot2c_f32_bf16 v98, s46, v90
    v_dot2c_f32_bf16 v102, v90, v90
    v_dot2c_f32_bf16 v99, s46, v91
    v_dot2c_f32_bf16 v103, v91, v91
    ds_read_b128 v[84:87], v116 offset:0
    ds_read_b64_tr_b16 v[48:49], v243 offset:0
    ds_read_b64_tr_b16 v[50:51], v243 offset:512
    ds_read_b64_tr_b16 v[52:53], v243 offset:8192
    ds_read_b64_tr_b16 v[54:55], v243 offset:8704
    ds_read_b64_tr_b16 v[56:57], v243 offset:16384
    ds_read_b64_tr_b16 v[58:59], v243 offset:16896
    s_waitcnt lgkmcnt(7)
    v_mfma_f32_32x32x16_bf16 v[0:15], v[72:75], v[92:95], v[0:15]
    s_add_u32 m0, s33, 81920
    s_add_u32 s47, s31, 1024
    buffer_load_dwordx4 v112, s[16:19], s47 offen lds
    v_mfma_f32_32x32x16_bf16 v[16:31], v[76:79], v[92:95], v[16:31]
    s_add_u32 s47, s32, 1024
    buffer_load_dwordx4 v112, s[16:19], s47 offen offset:1024 lds
    v_mfma_f32_32x32x16_bf16 v[32:47], v[92:95], v[80:83], v[32:47]
    s_add_u32 m0, s33, 90112
    s_add_u32 s47, s31, 2048
    buffer_load_dwordx4 v112, s[16:19], s47 offen lds
    v_dot2c_f32_bf16 v104, s46, v72
    v_dot2c_f32_bf16 v105, s46, v76
    v_dot2c_f32_bf16 v106, s46, v80
    v_dot2c_f32_bf16 v104, s46, v73
    v_dot2c_f32_bf16 v105, s46, v77
    v_dot2c_f32_bf16 v106, s46, v81
    v_dot2c_f32_bf16 v104, s46, v74
    v_dot2c_f32_bf16 v105, s46, v78
    v_dot2c_f32_bf16 v106, s46, v82
    v_dot2c_f32_bf16 v104, s46, v75
    v_dot2c_f32_bf16 v105, s46, v79
    v_dot2c_f32_bf16 v106, s46, v83
    s_waitcnt vmcnt(7)
    s_barrier
    ds_read_b128 v[88:91], v113 offset:32768
    ds_read_b64_tr_b16 v[60:61], v240 offset:32768
    ds_read_b64_tr_b16 v[62:63], v240 offset:33280
    ds_read_b64_tr_b16 v[64:65], v240 offset:40960
    ds_read_b64_tr_b16 v[66:67], v240 offset:41472
    ds_read_b64_tr_b16 v[68:69], v240 offset:49152
    ds_read_b64_tr_b16 v[70:71], v240 offset:49664
    s_waitcnt lgkmcnt(7)
    v_mfma_f32_32x32x16_bf16 v[0:15], v[48:51], v[84:87], v[0:15]
    s_add_u32 s47, s32, 2048
    buffer_load_dwordx4 v112, s[16:19], s47 offen offset:1024 lds
    s_add_u32 s31, s31, 196608
    s_add_u32 s32, s32, 196608
    v_mfma_f32_32x32x16_bf16 v[16:31], v[52:55], v[84:87], v[16:31]
    s_add_u32 m0, s33, 98304
    s_nop 0
    buffer_load_dwordx4 v110, s[12:15], s29 offen lds
    v_mfma_f32_32x32x16_bf16 v[32:47], v[84:87], v[56:59], v[32:47]
    buffer_load_dwordx4 v111, s[12:15], s30 offen offset:1024 lds
    s_add_u32 s29, s29, 128
    s_add_u32 s30, s30, 128
    ds_read_b128 v[92:95], v114 offset:32768
    ds_read_b64_tr_b16 v[72:73], v241 offset:32768
    ds_read_b64_tr_b16 v[74:75], v241 offset:33280
    ds_read_b64_tr_b16 v[76:77], v241 offset:40960
    ds_read_b64_tr_b16 v[78:79], v241 offset:41472
    ds_read_b64_tr_b16 v[80:81], v241 offset:49152
    ds_read_b64_tr_b16 v[82:83], v241 offset:49664
    s_waitcnt lgkmcnt(7)
    v_mfma_f32_32x32x16_bf16 v[0:15], v[60:63], v[88:91], v[0:15]
    s_add_u32 m0, s33, 106496
    s_add_u32 s47, s31, 0
    buffer_load_dwordx4 v112, s[16:19], s47 offen lds
    v_mfma_f32_32x32x16_bf16 v[16:31], v[64:67], v[88:91], v[16:31]
    s_add_u32 s47, s32, 0
    buffer_load_dwordx4 v112, s[16:19], s47 offen offset:1024 lds
    v_mfma_f32_32x32x16_bf16 v[32:47], v[88:91], v[68:71], v[32:47]
    s_add_u32 m0, s33, 114688
    s_add_u32 s47, s31, 1024
    buffer_load_dwordx4 v112, s[16:19], s47 offen lds
    v_dot2c_f32_bf16 v96, s46, v88
    v_dot2c_f32_bf16 v100, v88, v88
    v_dot2c_f32_bf16 v97, s46, v89
    v_dot2c_f32_bf16 v101, v89, v89
    v_dot2c_f32_bf16 v98, s46, v90
    v_dot2c_f32_bf16 v102, v90, v90
    v_dot2c_f32_bf16 v99, s46, v91
    v_dot2c_f32_bf16 v103, v91, v91
    v_dot2c_f32_bf16 v104, s46, v60
    v_dot2c_f32_bf16 v105, s46, v64
    v_dot2c_f32_bf16 v106, s46, v68
    v_dot2c_f32_bf16 v104, s46, v61
    v_dot2c_f32_bf16 v105, s46, v65
    v_dot2c_f32_bf16 v106, s46, v69
    v_dot2c_f32_bf16 v104, s46, v62
    v_dot2c_f32_bf16 v105, s46, v66
    v_dot2c_f32_bf16 v106, s46, v70
    v_dot2c_f32_bf16 v104, s46, v63
    v_dot2c_f32_bf16 v105, s46, v67
    v_dot2c_f32_bf16 v106, s46, v71
    ds_read_b128 v[84:87], v115 offset:32768
    ds_read_b64_tr_b16 v[48:49], v242 offset:32768
    ds_read_b64_tr_b16 v[50:51], v242 offset:33280
    ds_read_b64_tr_b16 v[52:53], v242 offset:40960
    ds_read_b64_tr_b16 v[54:55], v242 offset:41472
    ds_read_b64_tr_b16 v[56:57], v242 offset:49152
    ds_read_b64_tr_b16 v[58:59], v242 offset:49664
    s_waitcnt lgkmcnt(7)
    v_mfma_f32_32x32x16_bf16 v[0:15], v[72:75], v[92:95], v[0:15]
    s_add_u32 s47, s32, 1024
    buffer_load_dwordx4 v112, s[16:19], s47 offen offset:1024 lds
    v_mfma_f32_32x32x16_bf16 v[16:31], v[76:79], v[92:95], v[16:31]
    s_add_u32 m0, s33, 122880
    s_add_u32 s47, s31, 2048
    buffer_load_dwordx4 v112, s[16:19], s47 offen lds
    v_mfma_f32_32x32x16_bf16 v[32:47], v[92:95], v[80:83], v[32:47]
    s_add_u32 s47, s32, 2048
    buffer_load_dwordx4 v112, s[16:19], s47 offen offset:1024 lds
    s_add_u32 s31, s31, 196608
    s_add_u32 s32, s32, 196608
    v_dot2c_f32_bf16 v96, s46, v92
    v_dot2c_f32_bf16 v100, v92, v92
    v_dot2c_f32_bf16 v97, s46, v93
    v_dot2c_f32_bf16 v101, v93, v93
    v_dot2c_f32_bf16 v98, s46, v94
    v_dot2c_f32_bf16 v102, v94, v94
    v_dot2c_f32_bf16 v99, s46, v95
    v_dot2c_f32_bf16 v103, v95, v95
    ds_read_b128 v[88:91], v116 offset:32768
    ds_read_b64_tr_b16 v[60:61], v243 offset:32768
    ds_read_b64_tr_b16 v[62:63], v243 offset:33280
    ds_read_b64_tr_b16 v[64:65], v243 offset:40960
    ds_read_b64_tr_b16 v[66:67], v243 offset:41472
    ds_read_b64_tr_b16 v[68:69], v243 offset:49152
    ds_read_b64_tr_b16 v[70:71], v243 offset:49664
    s_waitcnt lgkmcnt(7)
    v_mfma_f32_32x32x16_bf16 v[0:15], v[48:51], v[84:87], v[0:15]
    v_mfma_f32_32x32x16_bf16 v[16:31], v[52:55], v[84:87], v[16:31]
    v_mfma_f32_32x32x16_bf16 v[32:47], v[84:87], v[56:59], v[32:47]
    v_dot2c_f32_bf16 v104, s46, v48
    v_dot2c_f32_bf16 v105, s46, v52
    v_dot2c_f32_bf16 v106, s46, v56
    v_dot2c_f32_bf16 v104, s46, v49
    v_dot2c_f32_bf16 v105, s46, v53
    v_dot2c_f32_bf16 v106, s46, v57
    v_dot2c_f32_bf16 v104, s46, v50
    v_dot2c_f32_bf16 v105, s46, v54
    v_dot2c_f32_bf16 v106, s46, v58
    v_dot2c_f32_bf16 v104, s46, v51
    v_dot2c_f32_bf16 v105, s46, v55
    v_dot2c_f32_bf16 v106, s46, v59
    s_waitcnt vmcnt(8)
    s_barrier
    ds_read_b128 v[92:95], v117 offset:0
    ds_read_b64_tr_b16 v[72:73], v244 offset:0
    ds_read_b64_tr_b16 v[74:75], v244 offset:512
    ds_read_b64_tr_b16 v[76:77], v244 offset:8192
    ds_read_b64_tr_b16 v[78:79], v244 offset:8704
    ds_read_b64_tr_b16 v[80:81], v244 offset:16384
    ds_read_b64_tr_b16 v[82:83], v244 offset:16896
    s_waitcnt lgkmcnt(7)
    v_mfma_f32_32x32x16_bf16 v[0:15], v[60:63], v[88:91], v[0:15]
    s_add_u32 m0, s33, 0
    s_nop 0
    buffer_load_dwordx4 v110, s[12:15], s29 offen lds
    v_mfma_f32_32x32x16_bf16 v[16:31], v[64:67], v[88:91], v[16:31]
    buffer_load_dwordx4 v111, s[12:15], s30 offen offset:1024 lds
    s_add_u32 s29, s29, 128
    s_add_u32 s30, s30, 128
    v_mfma_f32_32x32x16_bf16 v[32:47], v[88:91], v[68:71], v[32:47]
    s_add_u32 m0, s33, 8192
    s_add_u32 s47, s31, 0
    buffer_load_dwordx4 v112, s[16:19], s47 offen lds
    ds_read_b128 v[84:87], v118 offset:0
    ds_read_b64_tr_b16 v[48:49], v245 offset:0
    ds_read_b64_tr_b16 v[50:51], v245 offset:512
    ds_read_b64_tr_b16 v[52:53], v245 offset:8192
    ds_read_b64_tr_b16 v[54:55], v245 offset:8704
    ds_read_b64_tr_b16 v[56:57], v245 offset:16384
    ds_read_b64_tr_b16 v[58:59], v245 offset:16896
    s_waitcnt lgkmcnt(7)
    v_mfma_f32_32x32x16_bf16 v[0:15], v[72:75], v[92:95], v[0:15]
    s_add_u32 s47, s32, 0
    buffer_load_dwordx4 v112, s[16:19], s47 offen offset:1024 lds
    v_mfma_f32_32x32x16_bf16 v[16:31], v[76:79], v[92:95], v[16:31]
    s_add_u32 m0, s33, 16384
    s_add_u32 s47, s31, 1024
    buffer_load_dwordx4 v112, s[16:19], s47 offen lds
    v_mfma_f32_32x32x16_bf16 v[32:47], v[92:95], v[80:83], v[32:47]
    s_add_u32 s47, s32, 1024
    buffer_load_dwordx4 v112, s[16:19], s47 offen offset:1024 lds
    v_dot2c_f32_bf16 v96, s46, v92
    v_dot2c_f32_bf16 v100, v92, v92
    v_dot2c_f32_bf16 v97, s46, v93
    v_dot2c_f32_bf16 v101, v93, v93
    v_dot2c_f32_bf16 v98, s46, v94
    v_dot2c_f32_bf16 v102, v94, v94
    v_dot2c_f32_bf16 v99, s46, v95
    v_dot2c_f32_bf16 v103, v95, v95
    v_dot2c_f32_bf16 v104, s46, v72
    v_dot2c_f32_bf16 v105, s46, v76
    v_dot2c_f32_bf16 v106, s46, v80
    v_dot2c_f32_bf16 v104, s46, v73
    v_dot2c_f32_bf16 v105, s46, v77
    v_dot2c_f32_bf16 v106, s46, v81
    v_dot2c_f32_bf16 v104, s46, v74
    v_dot2c_f32_bf16 v105, s46, v78
    v_dot2c_f32_bf16 v106, s46, v82
    v_dot2c_f32_bf16 v104, s46, v75
    v_dot2c_f32_bf16 v105, s46, v79
    v_dot2c_f32_bf16 v106, s46, v83
    ds_read_b128 v[88:91], v119 offset:0
    ds_read_b64_tr_b16 v[60:61], v246 offset:0
    ds_read_b64_tr_b16 v[62:63], v246 offset:512
    ds_read_b64_tr_b16 v[64:65], v246 offset:8192
    ds_read_b64_tr_b16 v[66:67], v246 offset:8704
    ds_read_b64_tr_b16 v[68:69], v246 offset:16384
    ds_read_b64_tr_b16 v[70:71], v246 offset:16896
    s_waitcnt lgkmcnt(7)
    v_mfma_f32_32x32x16_bf16 v[0:15], v[48:51], v[84:87], v[0:15]
    s_add_u32 m0, s33, 24576
    s_add_u32 s47, s31, 2048
    buffer_load_dwordx4 v112, s[16:19], s47 offen lds
    v_mfma_f32_32x32x16_bf16 v[16:31], v[52:55], v[84:87], v[16:31]
    s_add_u32 s47, s32, 2048
    buffer_load_dwordx4 v112, s[16:19], s47 offen offset:1024 lds
    s_add_u32 s31, s31, 196608
    s_add_u32 s32, s32, 196608
    v_mfma_f32_32x32x16_bf16 v[32:47], v[84:87], v[56:59], v[32:47]
    v_dot2c_f32_bf16 v96, s46, v84
    v_dot2c_f32_bf16 v100, v84, v84
    v_dot2c_f32_bf16 v97, s46, v85
    v_dot2c_f32_bf16 v101, v85, v85
    v_dot2c_f32_bf16 v98, s46, v86
    v_dot2c_f32_bf16 v102, v86, v86
    v_dot2c_f32_bf16 v99, s46, v87
    v_dot2c_f32_bf16 v103, v87, v87
    ds_read_b128 v[92:95], v120 offset:0
    ds_read_b64_tr_b16 v[72:73], v247 offset:0
    ds_read_b64_tr_b16 v[74:75], v247 offset:512
    ds_read_b64_tr_b16 v[76:77], v247 offset:8192
    ds_read_b64_tr_b16 v[78:79], v247 offset:8704
    ds_read_b64_tr_b16 v[80:81], v247 offset:16384
    ds_read_b64_tr_b16 v[82:83], v247 offset:16896
    s_waitcnt lgkmcnt(7)
    v_mfma_f32_32x32x16_bf16 v[0:15], v[60:63], v[88:91], v[0:15]
    v_mfma_f32_32x32x16_bf16 v[16:31], v[64:67], v[88:91], v[16:31]
    v_mfma_f32_32x32x16_bf16 v[32:47], v[88:91], v[68:71], v[32:47]
    v_dot2c_f32_bf16 v104, s46, v60
    v_dot2c_f32_bf16 v105, s46, v64
    v_dot2c_f32_bf16 v106, s46, v68
    v_dot2c_f32_bf16 v104, s46, v61
    v_dot2c_f32_bf16 v105, s46, v65
    v_dot2c_f32_bf16 v106, s46, v69
    v_dot2c_f32_bf16 v104, s46, v62
    v_dot2c_f32_bf16 v105, s46, v66
    v_dot2c_f32_bf16 v106, s46, v70
    v_dot2c_f32_bf16 v104, s46, v63
    v_dot2c_f32_bf16 v105, s46, v67
    v_dot2c_f32_bf16 v106, s46, v71
    s_waitcnt vmcnt(8)
    s_barrier
    ds_read_b128 v[84:87], v117 offset:32768
    ds_read_b64_tr_b16 v[48:49], v244 offset:32768
    ds_read_b64_tr_b16 v[50:51], v244 offset:33280
    ds_read_b64_tr_b16 v[52:53], v244 offset:40960
    ds_read_b64_tr_b16 v[54:55], v244 offset:41472
    ds_read_b64_tr_b16 v[56:57], v244 offset:49152
    ds_read_b64_tr_b16 v[58:59], v244 offset:49664
    s_waitcnt lgkmcnt(7)
    v_mfma_f32_32x32x16_bf16 v[0:15], v[72:75], v[92:95], v[0:15]
    s_add_u32 m0, s33, 32768
    s_nop 0
    buffer_load_dwordx4 v110, s[12:15], s29 offen lds
    v_mfma_f32_32x32x16_bf16 v[16:31], v[76:79], v[92:95], v[16:31]
    buffer_load_dwordx4 v111, s[12:15], s30 offen offset:1024 lds
    s_add_u32 s29, s29, 128
    s_add_u32 s30, s30, 128
    v_mfma_f32_32x32x16_bf16 v[32:47], v[92:95], v[80:83], v[32:47]
    s_add_u32 m0, s33, 40960
    s_add_u32 s47, s31, 0
    buffer_load_dwordx4 v112, s[16:19], s47 offen lds
    ds_read_b128 v[88:91], v118 offset:32768
    ds_read_b64_tr_b16 v[60:61], v245 offset:32768
    ds_read_b64_tr_b16 v[62:63], v245 offset:33280
    ds_read_b64_tr_b16 v[64:65], v245 offset:40960
    ds_read_b64_tr_b16 v[66:67], v245 offset:41472
    ds_read_b64_tr_b16 v[68:69], v245 offset:49152
    ds_read_b64_tr_b16 v[70:71], v245 offset:49664
    s_waitcnt lgkmcnt(7)
    v_mfma_f32_32x32x16_bf16 v[0:15], v[48:51], v[84:87], v[0:15]
    s_add_u32 s47, s32, 0
    buffer_load_dwordx4 v112, s[16:19], s47 offen offset:1024 lds
    v_mfma_f32_32x32x16_bf16 v[16:31], v[52:55], v[84:87], v[16:31]
    s_add_u32 m0, s33, 49152
    s_add_u32 s47, s31, 1024
    buffer_load_dwordx4 v112, s[16:19], s47 offen lds
    v_mfma_f32_32x32x16_bf16 v[32:47], v[84:87], v[56:59], v[32:47]
    s_add_u32 s47, s32, 1024
    buffer_load_dwordx4 v112, s[16:19], s47 offen offset:1024 lds
    v_dot2c_f32_bf16 v96, s46, v84
    v_dot2c_f32_bf16 v100, v84, v84
    v_dot2c_f32_bf16 v97, s46, v85
    v_dot2c_f32_bf16 v101, v85, v85
    v_dot2c_f32_bf16 v98, s46, v86
    v_dot2c_f32_bf16 v102, v86, v86
    v_dot2c_f32_bf16 v99, s46, v87
    v_dot2c_f32_bf16 v103, v87, v87
    v_dot2c_f32_bf16 v104, s46, v48
    v_dot2c_f32_bf16 v105, s46, v52
    v_dot2c_f32_bf16 v106, s46, v56
    v_dot2c_f32_bf16 v104, s46, v49
    v_dot2c_f32_bf16 v105, s46, v53
    v_dot2c_f32_bf16 v106, s46, v57
    v_dot2c_f32_bf16 v104, s46, v50
    v_dot2c_f32_bf16 v105, s46, v54
    v_dot2c_f32_bf16 v106, s46, v58
    v_dot2c_f32_bf16 v104, s46, v51
    v_dot2c_f32_bf16 v105, s46, v55
    v_dot2c_f32_bf16 v106, s46, v59
    ds_read_b128 v[92:95], v119 offset:32768
    ds_read_b64_tr_b16 v[72:73], v246 offset:32768
    ds_read_b64_tr_b16 v[74:75], v246 offset:33280
    ds_read_b64_tr_b16 v[76:77], v246 offset:40960
    ds_read_b64_tr_b16 v[78:79], v246 offset:41472
    ds_read_b64_tr_b16 v[80:81], v246 offset:49152
    ds_read_b64_tr_b16 v[82:83], v246 offset:49664
    s_waitcnt lgkmcnt(7)
    v_mfma_f32_32x32x16_bf16 v[0:15], v[60:63], v[88:91], v[0:15]
    s_add_u32 m0, s33, 57344
    s_add_u32 s47, s31, 2048
    buffer_load_dwordx4 v112, s[16:19], s47 offen lds
    v_mfma_f32_32x32x16_bf16 v[16:31], v[64:67], v[88:91], v[16:31]
    s_add_u32 s47, s32, 2048
    buffer_load_dwordx4 v112, s[16:19], s47 offen offset:1024 lds
    s_add_u32 s31, s31, 196608
    s_add_u32 s32, s32, 196608
    v_mfma_f32_32x32x16_bf16 v[32:47], v[88:91], v[68:71], v[32:47]
    v_dot2c_f32_bf16 v96, s46, v88
    v_dot2c_f32_bf16 v100, v88, v88
    v_dot2c_f32_bf16 v97, s46, v89
    v_dot2c_f32_bf16 v101, v89, v89
    v_dot2c_f32_bf16 v98, s46, v90
    v_dot2c_f32_bf16 v102, v90, v90
    v_dot2c_f32_bf16 v99, s46, v91
    v_dot2c_f32_bf16 v103, v91, v91
    ds_read_b128 v[84:87], v120 offset:32768
    ds_read_b64_tr_b16 v[48:49], v247 offset:32768
    ds_read_b64_tr_b16 v[50:51], v247 offset:33280
    ds_read_b64_tr_b16 v[52:53], v247 offset:40960
    ds_read_b64_tr_b16 v[54:55], v247 offset:41472
    ds_read_b64_tr_b16 v[56:57], v247 offset:49152
    ds_read_b64_tr_b16 v[58:59], v247 offset:49664
    s_waitcnt lgkmcnt(7)
    v_mfma_f32_32x32x16_bf16 v[0:15], v[72:75], v[92:95], v[0:15]
    v_mfma_f32_32x32x16_bf16 v[16:31], v[76:79], v[92:95], v[16:31]
    v_mfma_f32_32x32x16_bf16 v[32:47], v[92:95], v[80:83], v[32:47]
    v_dot2c_f32_bf16 v104, s46, v72
    v_dot2c_f32_bf16 v105, s46, v76
    v_dot2c_f32_bf16 v106, s46, v80
    v_dot2c_f32_bf16 v104, s46, v73
    v_dot2c_f32_bf16 v105, s46, v77
    v_dot2c_f32_bf16 v106, s46, v81
    v_dot2c_f32_bf16 v104, s46, v74
    v_dot2c_f32_bf16 v105, s46, v78
    v_dot2c_f32_bf16 v106, s46, v82
    v_dot2c_f32_bf16 v104, s46, v75
    v_dot2c_f32_bf16 v105, s46, v79
    v_dot2c_f32_bf16 v106, s46, v83
    s_waitcnt vmcnt(8)
    s_barrier
    ds_read_b128 v[88:91], v113 offset:0
    ds_read_b64_tr_b16 v[60:61], v240 offset:0
    ds_read_b64_tr_b16 v[62:63], v240 offset:512
    ds_read_b64_tr_b16 v[64:65], v240 offset:8192
    ds_read_b64_tr_b16 v[66:67], v240 offset:8704
    ds_read_b64_tr_b16 v[68:69], v240 offset:16384
    ds_read_b64_tr_b16 v[70:71], v240 offset:16896
    s_waitcnt lgkmcnt(7)
    v_mfma_f32_32x32x16_bf16 v[0:15], v[48:51], v[84:87], v[0:15]
    s_add_u32 m0, s33, 65536
    s_nop 0
    buffer_load_dwordx4 v110, s[12:15], s29 offen lds
    v_mfma_f32_32x32x16_bf16 v[16:31], v[52:55], v[84:87], v[16:31]
    buffer_load_dwordx4 v111, s[12:15], s30 offen offset:1024 lds
    s_add_u32 s29, s29, 128
    s_add_u32 s30, s30, 128
    v_mfma_f32_32x32x16_bf16 v[32:47], v[84:87], v[56:59], v[32:47]
    s_add_u32 m0, s33, 73728
    s_add_u32 s47, s31, 0
    buffer_load_dwordx4 v112, s[16:19], s47 offen lds
    ds_read_b128 v[92:95], v114 offset:0
    ds_read_b64_tr_b16 v[72:73], v241 offset:0
    ds_read_b64_tr_b16 v[74:75], v241 offset:512
    ds_read_b64_tr_b16 v[76:77], v241 offset:8192
    ds_read_b64_tr_b16 v[78:79], v241 offset:8704
    ds_read_b64_tr_b16 v[80:81], v241 offset:16384
    ds_read_b64_tr_b16 v[82:83], v241 offset:16896
    s_waitcnt lgkmcnt(7)
    v_mfma_f32_32x32x16_bf16 v[0:15], v[60:63], v[88:91], v[0:15]
    s_add_u32 s47, s32, 0
    buffer_load_dwordx4 v112, s[16:19], s47 offen offset:1024 lds
    v_mfma_f32_32x32x16_bf16 v[16:31], v[64:67], v[88:91], v[16:31]
    s_add_u32 m0, s33, 81920
    s_add_u32 s47, s31, 1024
    buffer_load_dwordx4 v112, s[16:19], s47 offen lds
    v_mfma_f32_32x32x16_bf16 v[32:47], v[88:91], v[68:71], v[32:47]
    s_add_u32 s47, s32, 1024
    buffer_load_dwordx4 v112, s[16:19], s47 offen offset:1024 lds
    v_dot2c_f32_bf16 v96, s46, v88
    v_dot2c_f32_bf16 v100, v88, v88
    v_dot2c_f32_bf16 v97, s46, v89
    v_dot2c_f32_bf16 v101, v89, v89
    v_dot2c_f32_bf16 v98, s46, v90
    v_dot2c_f32_bf16 v102, v90, v90
    v_dot2c_f32_bf16 v99, s46, v91
    v_dot2c_f32_bf16 v103, v91, v91
    v_dot2c_f32_bf16 v104, s46, v60
    v_dot2c_f32_bf16 v105, s46, v64
    v_dot2c_f32_bf16 v106, s46, v68
    v_dot2c_f32_bf16 v104, s46, v61
    v_dot2c_f32_bf16 v105, s46, v65
    v_dot2c_f32_bf16 v106, s46, v69
    v_dot2c_f32_bf16 v104, s46, v62
    v_dot2c_f32_bf16 v105, s46, v66
    v_dot2c_f32_bf16 v106, s46, v70
    v_dot2c_f32_bf16 v104, s46, v63
    v_dot2c_f32_bf16 v105, s46, v67
    v_dot2c_f32_bf16 v106, s46, v71
    ds_read_b128 v[84:87], v115 offset:0
    ds_read_b64_tr_b16 v[48:49], v242 offset:0
    ds_read_b64_tr_b16 v[50:51], v242 offset:512
    ds_read_b64_tr_b16 v[52:53], v242 offset:8192
    ds_read_b64_tr_b16 v[54:55], v242 offset:8704
    ds_read_b64_tr_b16 v[56:57], v242 offset:16384
    ds_read_b64_tr_b16 v[58:59], v242 offset:16896
    s_waitcnt lgkmcnt(7)
    v_mfma_f32_32x32x16_bf16 v[0:15], v[72:75], v[92:95], v[0:15]
    s_add_u32 m0, s33, 90112
    s_add_u32 s47, s31, 2048
    buffer_load_dwordx4 v112, s[16:19], s47 offen lds
    v_mfma_f32_32x32x16_bf16 v[16:31], v[76:79], v[92:95], v[16:31]
    s_add_u32 s47, s32, 2048
    buffer_load_dwordx4 v112, s[16:19], s47 offen offset:1024 lds
    s_add_u32 s31, s31, 196608
    s_add_u32 s32, s32, 196608
    v_mfma_f32_32x32x16_bf16 v[32:47], v[92:95], v[80:83], v[32:47]
    v_dot2c_f32_bf16 v96, s46, v92
    v_dot2c_f32_bf16 v100, v92, v92
    v_dot2c_f32_bf16 v97, s46, v93
    v_dot2c_f32_bf16 v101, v93, v93
    v_dot2c_f32_bf16 v98, s46, v94
    v_dot2c_f32_bf16 v102, v94, v94
    v_dot2c_f32_bf16 v99, s46, v95
    v_dot2c_f32_bf16 v103, v95, v95
    ds_read_b128 v[88:91], v116 offset:0
    ds_read_b64_tr_b16 v[60:61], v243 offset:0
    ds_read_b64_tr_b16 v[62:63], v243 offset:512
    ds_read_b64_tr_b16 v[64:65], v243 offset:8192
    ds_read_b64_tr_b16 v[66:67], v243 offset:8704
    ds_read_b64_tr_b16 v[68:69], v243 offset:16384
    ds_read_b64_tr_b16 v[70:71], v243 offset:16896
    s_waitcnt lgkmcnt(7)
    v_mfma_f32_32x32x16_bf16 v[0:15], v[48:51], v[84:87], v[0:15]
    v_mfma_f32_32x32x16_bf16 v[16:31], v[52:55], v[84:87], v[16:31]
    v_mfma_f32_32x32x16_bf16 v[32:47], v[84:87], v[56:59], v[32:47]
    v_dot2c_f32_bf16 v104, s46, v48
    v_dot2c_f32_bf16 v105, s46, v52
    v_dot2c_f32_bf16 v106, s46, v56
    v_dot2c_f32_bf16 v104, s46, v49
    v_dot2c_f32_bf16 v105, s46, v53
    v_dot2c_f32_bf16 v106, s46, v57
    v_dot2c_f32_bf16 v104, s46, v50
    v_dot2c_f32_bf16 v105, s46, v54
    v_dot2c_f32_bf16 v106, s46, v58
    v_dot2c_f32_bf16 v104, s46, v51
    v_dot2c_f32_bf16 v105, s46, v55
    v_dot2c_f32_bf16 v106, s46, v59
    s_waitcnt vmcnt(8)
    s_barrier
    ds_read_b128 v[92:95], v113 offset:32768
    ds_read_b64_tr_b16 v[72:73], v240 offset:32768
    ds_read_b64_tr_b16 v[74:75], v240 offset:33280
    ds_read_b64_tr_b16 v[76:77], v240 offset:40960
    ds_read_b64_tr_b16 v[78:79], v240 offset:41472
    ds_read_b64_tr_b16 v[80:81], v240 offset:49152
    ds_read_b64_tr_b16 v[82:83], v240 offset:49664
    s_waitcnt lgkmcnt(7)
    v_mfma_f32_32x32x16_bf16 v[0:15], v[60:63], v[88:91], v[0:15]
    s_add_u32 m0, s33, 98304
    s_nop 0
    buffer_load_dwordx4 v110, s[12:15], s29 offen lds
    v_mfma_f32_32x32x16_bf16 v[16:31], v[64:67], v[88:91], v[16:31]
    buffer_load_dwordx4 v111, s[12:15], s30 offen offset:1024 lds
    s_add_u32 s29, s29, 128
    s_add_u32 s30, s30, 128
    v_mfma_f32_32x32x16_bf16 v[32:47], v[88:91], v[68:71], v[32:47]
    s_add_u32 m0, s33, 106496
    s_add_u32 s47, s31, 0
    buffer_load_dwordx4 v112, s[16:19], s47 offen lds
    ds_read_b128 v[84:87], v114 offset:32768
    ds_read_b64_tr_b16 v[48:49], v241 offset:32768
    ds_read_b64_tr_b16 v[50:51], v241 offset:33280
    ds_read_b64_tr_b16 v[52:53], v241 offset:40960
    ds_read_b64_tr_b16 v[54:55], v241 offset:41472
    ds_read_b64_tr_b16 v[56:57], v241 offset:49152
    ds_read_b64_tr_b16 v[58:59], v241 offset:49664
    s_waitcnt lgkmcnt(7)
    v_mfma_f32_32x32x16_bf16 v[0:15], v[72:75], v[92:95], v[0:15]
    s_add_u32 s47, s32, 0
    buffer_load_dwordx4 v112, s[16:19], s47 offen offset:1024 lds
    v_mfma_f32_32x32x16_bf16 v[16:31], v[76:79], v[92:95], v[16:31]
    s_add_u32 m0, s33, 114688
    s_add_u32 s47, s31, 1024
    buffer_load_dwordx4 v112, s[16:19], s47 offen lds
    v_mfma_f32_32x32x16_bf16 v[32:47], v[92:95], v[80:83], v[32:47]
    s_add_u32 s47, s32, 1024
    buffer_load_dwordx4 v112, s[16:19], s47 offen offset:1024 lds
    v_dot2c_f32_bf16 v96, s46, v92
    v_dot2c_f32_bf16 v100, v92, v92
    v_dot2c_f32_bf16 v97, s46, v93
    v_dot2c_f32_bf16 v101, v93, v93
    v_dot2c_f32_bf16 v98, s46, v94
    v_dot2c_f32_bf16 v102, v94, v94
    v_dot2c_f32_bf16 v99, s46, v95
    v_dot2c_f32_bf16 v103, v95, v95
    v_dot2c_f32_bf16 v104, s46, v72
    v_dot2c_f32_bf16 v105, s46, v76
    v_dot2c_f32_bf16 v106, s46, v80
    v_dot2c_f32_bf16 v104, s46, v73
    v_dot2c_f32_bf16 v105, s46, v77
    v_dot2c_f32_bf16 v106, s46, v81
    v_dot2c_f32_bf16 v104, s46, v74
    v_dot2c_f32_bf16 v105, s46, v78
    v_dot2c_f32_bf16 v106, s46, v82
    v_dot2c_f32_bf16 v104, s46, v75
    v_dot2c_f32_bf16 v105, s46, v79
    v_dot2c_f32_bf16 v106, s46, v83
    ds_read_b128 v[88:91], v115 offset:32768
    ds_read_b64_tr_b16 v[60:61], v242 offset:32768
    ds_read_b64_tr_b16 v[62:63], v242 offset:33280
    ds_read_b64_tr_b16 v[64:65], v242 offset:40960
    ds_read_b64_tr_b16 v[66:67], v242 offset:41472
    ds_read_b64_tr_b16 v[68:69], v242 offset:49152
    ds_read_b64_tr_b16 v[70:71], v242 offset:49664
    s_waitcnt lgkmcnt(7)
    v_mfma_f32_32x32x16_bf16 v[0:15], v[48:51], v[84:87], v[0:15]
    s_add_u32 m0, s33, 122880
    s_add_u32 s47, s31, 2048
    buffer_load_dwordx4 v112, s[16:19], s47 offen lds
    v_mfma_f32_32x32x16_bf16 v[16:31], v[52:55], v[84:87], v[16:31]
    s_add_u32 s47, s32, 2048
    buffer_load_dwordx4 v112, s[16:19], s47 offen offset:1024 lds
    s_add_u32 s31, s31, 196608
    s_add_u32 s32, s32, 196608
    v_mfma_f32_32x32x16_bf16 v[32:47], v[84:87], v[56:59], v[32:47]
    v_dot2c_f32_bf16 v96, s46, v84
    v_dot2c_f32_bf16 v100, v84, v84
    v_dot2c_f32_bf16 v97, s46, v85
    v_dot2c_f32_bf16 v101, v85, v85
    v_dot2c_f32_bf16 v98, s46, v86
    v_dot2c_f32_bf16 v102, v86, v86
    v_dot2c_f32_bf16 v99, s46, v87
    v_dot2c_f32_bf16 v103, v87, v87
    ds_read_b128 v[92:95], v116 offset:32768
    ds_read_b64_tr_b16 v[72:73], v243 offset:32768
    ds_read_b64_tr_b16 v[74:75], v243 offset:33280
    ds_read_b64_tr_b16 v[76:77], v243 offset:40960
    ds_read_b64_tr_b16 v[78:79], v243 offset:41472
    ds_read_b64_tr_b16 v[80:81], v243 offset:49152
    ds_read_b64_tr_b16 v[82:83], v243 offset:49664
    s_waitcnt lgkmcnt(7)
    v_mfma_f32_32x32x16_bf16 v[0:15], v[60:63], v[88:91], v[0:15]
    v_mfma_f32_32x32x16_bf16 v[16:31], v[64:67], v[88:91], v[16:31]
    v_mfma_f32_32x32x16_bf16 v[32:47], v[88:91], v[68:71], v[32:47]
    v_dot2c_f32_bf16 v104, s46, v60
    v_dot2c_f32_bf16 v105, s46, v64
    v_dot2c_f32_bf16 v106, s46, v68
    v_dot2c_f32_bf16 v104, s46, v61
    v_dot2c_f32_bf16 v105, s46, v65
    v_dot2c_f32_bf16 v106, s46, v69
    v_dot2c_f32_bf16 v104, s46, v62
    v_dot2c_f32_bf16 v105, s46, v66
    v_dot2c_f32_bf16 v106, s46, v70
    v_dot2c_f32_bf16 v104, s46, v63
    v_dot2c_f32_bf16 v105, s46, v67
    v_dot2c_f32_bf16 v106, s46, v71
    s_waitcnt vmcnt(8)
    s_barrier
    ds_read_b128 v[84:87], v117 offset:0
    ds_read_b64_tr_b16 v[48:49], v244 offset:0
    ds_read_b64_tr_b16 v[50:51], v244 offset:512
    ds_read_b64_tr_b16 v[52:53], v244 offset:8192
    ds_read_b64_tr_b16 v[54:55], v244 offset:8704
    ds_read_b64_tr_b16 v[56:57], v244 offset:16384
    ds_read_b64_tr_b16 v[58:59], v244 offset:16896
    s_waitcnt lgkmcnt(7)
    v_mfma_f32_32x32x16_bf16 v[0:15], v[72:75], v[92:95], v[0:15]
    v_mfma_f32_32x32x16_bf16 v[16:31], v[76:79], v[92:95], v[16:31]
    v_mfma_f32_32x32x16_bf16 v[32:47], v[92:95], v[80:83], v[32:47]
    ds_read_b128 v[88:91], v118 offset:0
    ds_read_b64_tr_b16 v[60:61], v245 offset:0
    ds_read_b64_tr_b16 v[62:63], v245 offset:512
    ds_read_b64_tr_b16 v[64:65], v245 offset:8192
    ds_read_b64_tr_b16 v[66:67], v245 offset:8704
    ds_read_b64_tr_b16 v[68:69], v245 offset:16384
    ds_read_b64_tr_b16 v[70:71], v245 offset:16896
    s_waitcnt lgkmcnt(7)
    v_mfma_f32_32x32x16_bf16 v[0:15], v[48:51], v[84:87], v[0:15]
    v_mfma_f32_32x32x16_bf16 v[16:31], v[52:55], v[84:87], v[16:31]
    v_mfma_f32_32x32x16_bf16 v[32:47], v[84:87], v[56:59], v[32:47]
    v_dot2c_f32_bf16 v96, s46, v84
    v_dot2c_f32_bf16 v100, v84, v84
    v_dot2c_f32_bf16 v97, s46, v85
    v_dot2c_f32_bf16 v101, v85, v85
    v_dot2c_f32_bf16 v98, s46, v86
    v_dot2c_f32_bf16 v102, v86, v86
    v_dot2c_f32_bf16 v99, s46, v87
    v_dot2c_f32_bf16 v103, v87, v87
    v_dot2c_f32_bf16 v104, s46, v48
    v_dot2c_f32_bf16 v105, s46, v52
    v_dot2c_f32_bf16 v106, s46, v56
    v_dot2c_f32_bf16 v104, s46, v49
    v_dot2c_f32_bf16 v105, s46, v53
    v_dot2c_f32_bf16 v106, s46, v57
    v_dot2c_f32_bf16 v104, s46, v50
    v_dot2c_f32_bf16 v105, s46, v54
    v_dot2c_f32_bf16 v106, s46, v58
    v_dot2c_f32_bf16 v104, s46, v51
    v_dot2c_f32_bf16 v105, s46, v55
    v_dot2c_f32_bf16 v106, s46, v59
    ds_read_b128 v[92:95], v119 offset:0
    ds_read_b64_tr_b16 v[72:73], v246 offset:0
    ds_read_b64_tr_b16 v[74:75], v246 offset:512
    ds_read_b64_tr_b16 v[76:77], v246 offset:8192
    ds_read_b64_tr_b16 v[78:79], v246 offset:8704
    ds_read_b64_tr_b16 v[80:81], v246 offset:16384
    ds_read_b64_tr_b16 v[82:83], v246 offset:16896
    s_waitcnt lgkmcnt(7)
    v_mfma_f32_32x32x16_bf16 v[0:15], v[60:63], v[88:91], v[0:15]
    v_mfma_f32_32x32x16_bf16 v[16:31], v[64:67], v[88:91], v[16:31]
    v_mfma_f32_32x32x16_bf16 v[32:47], v[88:91], v[68:71], v[32:47]
    v_dot2c_f32_bf16 v96, s46, v88
    v_dot2c_f32_bf16 v100, v88, v88
    v_dot2c_f32_bf16 v97, s46, v89
    v_dot2c_f32_bf16 v101, v89, v89
    v_dot2c_f32_bf16 v98, s46, v90
    v_dot2c_f32_bf16 v102, v90, v90
    v_dot2c_f32_bf16 v99, s46, v91
    v_dot2c_f32_bf16 v103, v91, v91
    ds_read_b128 v[84:87], v120 offset:0
    ds_read_b64_tr_b16 v[48:49], v247 offset:0
    ds_read_b64_tr_b16 v[50:51], v247 offset:512
    ds_read_b64_tr_b16 v[52:53], v247 offset:8192
    ds_read_b64_tr_b16 v[54:55], v247 offset:8704
    ds_read_b64_tr_b16 v[56:57], v247 offset:16384
    ds_read_b64_tr_b16 v[58:59], v247 offset:16896
    s_waitcnt lgkmcnt(7)
    v_mfma_f32_32x32x16_bf16 v[0:15], v[72:75], v[92:95], v[0:15]
    v_mfma_f32_32x32x16_bf16 v[16:31], v[76:79], v[92:95], v[16:31]
    v_mfma_f32_32x32x16_bf16 v[32:47], v[92:95], v[80:83], v[32:47]
    v_dot2c_f32_bf16 v104, s46, v72
    v_dot2c_f32_bf16 v105, s46, v76
    v_dot2c_f32_bf16 v106, s46, v80
    v_dot2c_f32_bf16 v104, s46, v73
    v_dot2c_f32_bf16 v105, s46, v77
    v_dot2c_f32_bf16 v106, s46, v81
    v_dot2c_f32_bf16 v104, s46, v74
    v_dot2c_f32_bf16 v105, s46, v78
    v_dot2c_f32_bf16 v106, s46, v82
    v_dot2c_f32_bf16 v104, s46, v75
    v_dot2c_f32_bf16 v105, s46, v79
    v_dot2c_f32_bf16 v106, s46, v83
    s_waitcnt vmcnt(0)
    s_barrier
    ds_read_b128 v[88:91], v117 offset:32768
    ds_read_b64_tr_b16 v[60:61], v244 offset:32768
    ds_read_b64_tr_b16 v[62:63], v244 offset:33280
    ds_read_b64_tr_b16 v[64:65], v244 offset:40960
    ds_read_b64_tr_b16 v[66:67], v244 offset:41472
    ds_read_b64_tr_b16 v[68:69], v244 offset:49152
    ds_read_b64_tr_b16 v[70:71], v244 offset:49664
    s_waitcnt lgkmcnt(7)
    v_mfma_f32_32x32x16_bf16 v[0:15], v[48:51], v[84:87], v[0:15]
    v_mfma_f32_32x32x16_bf16 v[16:31], v[52:55], v[84:87], v[16:31]
    v_mfma_f32_32x32x16_bf16 v[32:47], v[84:87], v[56:59], v[32:47]
    ds_read_b128 v[92:95], v118 offset:32768
    ds_read_b64_tr_b16 v[72:73], v245 offset:32768
    ds_read_b64_tr_b16 v[74:75], v245 offset:33280
    ds_read_b64_tr_b16 v[76:77], v245 offset:40960
    ds_read_b64_tr_b16 v[78:79], v245 offset:41472
    ds_read_b64_tr_b16 v[80:81], v245 offset:49152
    ds_read_b64_tr_b16 v[82:83], v245 offset:49664
    s_waitcnt lgkmcnt(7)
    v_mfma_f32_32x32x16_bf16 v[0:15], v[60:63], v[88:91], v[0:15]
    v_mfma_f32_32x32x16_bf16 v[16:31], v[64:67], v[88:91], v[16:31]
    v_mfma_f32_32x32x16_bf16 v[32:47], v[88:91], v[68:71], v[32:47]
    v_dot2c_f32_bf16 v96, s46, v88
    v_dot2c_f32_bf16 v100, v88, v88
    v_dot2c_f32_bf16 v97, s46, v89
    v_dot2c_f32_bf16 v101, v89, v89
    v_dot2c_f32_bf16 v98, s46, v90
    v_dot2c_f32_bf16 v102, v90, v90
    v_dot2c_f32_bf16 v99, s46, v91
    v_dot2c_f32_bf16 v103, v91, v91
    v_dot2c_f32_bf16 v104, s46, v60
    v_dot2c_f32_bf16 v105, s46, v64
    v_dot2c_f32_bf16 v106, s46, v68
    v_dot2c_f32_bf16 v104, s46, v61
    v_dot2c_f32_bf16 v105, s46, v65
    v_dot2c_f32_bf16 v106, s46, v69
    v_dot2c_f32_bf16 v104, s46, v62
    v_dot2c_f32_bf16 v105, s46, v66
    v_dot2c_f32_bf16 v106, s46, v70
    v_dot2c_f32_bf16 v104, s46, v63
    v_dot2c_f32_bf16 v105, s46, v67
    v_dot2c_f32_bf16 v106, s46, v71
    ds_read_b128 v[84:87], v119 offset:32768
    ds_read_b64_tr_b16 v[48:49], v246 offset:32768
    ds_read_b64_tr_b16 v[50:51], v246 offset:33280
    ds_read_b64_tr_b16 v[52:53], v246 offset:40960
    ds_read_b64_tr_b16 v[54:55], v246 offset:41472
    ds_read_b64_tr_b16 v[56:57], v246 offset:49152
    ds_read_b64_tr_b16 v[58:59], v246 offset:49664
    s_waitcnt lgkmcnt(7)
    v_mfma_f32_32x32x16_bf16 v[0:15], v[72:75], v[92:95], v[0:15]
    v_mfma_f32_32x32x16_bf16 v[16:31], v[76:79], v[92:95], v[16:31]
    v_mfma_f32_32x32x16_bf16 v[32:47], v[92:95], v[80:83], v[32:47]
    v_dot2c_f32_bf16 v96, s46, v92
    v_dot2c_f32_bf16 v100, v92, v92
    v_dot2c_f32_bf16 v97, s46, v93
    v_dot2c_f32_bf16 v101, v93, v93
    v_dot2c_f32_bf16 v98, s46, v94
    v_dot2c_f32_bf16 v102, v94, v94
    v_dot2c_f32_bf16 v99, s46, v95
    v_dot2c_f32_bf16 v103, v95, v95
    ds_read_b128 v[88:91], v120 offset:32768
    ds_read_b64_tr_b16 v[60:61], v247 offset:32768
    ds_read_b64_tr_b16 v[62:63], v247 offset:33280
    ds_read_b64_tr_b16 v[64:65], v247 offset:40960
    ds_read_b64_tr_b16 v[66:67], v247 offset:41472
    ds_read_b64_tr_b16 v[68:69], v247 offset:49152
    ds_read_b64_tr_b16 v[70:71], v247 offset:49664
    s_waitcnt lgkmcnt(7)
    v_mfma_f32_32x32x16_bf16 v[0:15], v[48:51], v[84:87], v[0:15]
    v_mfma_f32_32x32x16_bf16 v[16:31], v[52:55], v[84:87], v[16:31]
    v_mfma_f32_32x32x16_bf16 v[32:47], v[84:87], v[56:59], v[32:47]
    v_dot2c_f32_bf16 v104, s46, v48
    v_dot2c_f32_bf16 v105, s46, v52
    v_dot2c_f32_bf16 v106, s46, v56
    v_dot2c_f32_bf16 v104, s46, v49
    v_dot2c_f32_bf16 v105, s46, v53
    v_dot2c_f32_bf16 v106, s46, v57
    v_dot2c_f32_bf16 v104, s46, v50
    v_dot2c_f32_bf16 v105, s46, v54
    v_dot2c_f32_bf16 v106, s46, v58
    v_dot2c_f32_bf16 v104, s46, v51
    v_dot2c_f32_bf16 v105, s46, v55
    v_dot2c_f32_bf16 v106, s46, v59
    s_waitcnt lgkmcnt(0)
    v_mfma_f32_32x32x16_bf16 v[0:15], v[60:63], v[88:91], v[0:15]
    v_mfma_f32_32x32x16_bf16 v[16:31], v[64:67], v[88:91], v[16:31]
    v_mfma_f32_32x32x16_bf16 v[32:47], v[88:91], v[68:71], v[32:47]
    s_nop 2
    v_add_f32 v104, v104, v250
    v_add_f32 v105, v105, v251
    v_add_f32 v106, v106, v252
    v_cvt_f64_f32 v[144:145], v96
    v_cvt_f64_f32 v[146:147], v97
    v_cvt_f64_f32 v[148:149], v98
    v_cvt_f64_f32 v[150:151], v99
    v_cvt_f64_f32 v[152:153], v100
    v_cvt_f64_f32 v[154:155], v101
    v_cvt_f64_f32 v[156:157], v102
    v_cvt_f64_f32 v[158:159], v103
    s_lshl_b32 s34, s26, 11
    s_add_u32 s34, s34, 131072
    v_add_u32 v126, s34, v109
    ds_write_b128 v126, v[104:107] offset:1024
    v_add_f64 v[144:145], v[144:145], v[146:147]
    v_add_f64 v[148:149], v[148:149], v[150:151]
    v_add_f64 v[152:153], v[152:153], v[154:155]
    v_add_f64 v[156:157], v[156:157], v[158:159]
    v_add_f64 v[144:145], v[144:145], v[148:149]
    v_add_f64 v[146:147], v[152:153], v[156:157]
    v_xor_b32 v127, 4096, v126
    v_xor_b32 v128, 2048, v126
    ds_write_b128 v126, v[144:147]
    s_lshl_b32 s34, s26, 9
    s_add_u32 s35, s34, 139264
    v_lshl_add_u32 v129, v124, 2, s35
    v_lshl_add_u32 v130, v125, 4, s35
    s_waitcnt lgkmcnt(0)
    s_barrier
    ds_read_b128 v[240:243], v128 offset:1024
    ds_read_b128 v[148:151], v127
    s_waitcnt lgkmcnt(1)
    v_add_f32 v104, v104, v240
    v_add_f32 v105, v105, v241
    v_add_f32 v106, v106, v242
    v_mov_b32 v126, v104
    v_mov_b32 v127, v105
    v_mov_b32 v128, v106
    s_nop 1
    v_permlane32_swap_b32 v104, v126
    v_permlane32_swap_b32 v105, v127
    v_permlane32_swap_b32 v106, v128
    s_nop 1
    v_add_f32 v104, v104, v126
    v_add_f32 v105, v105, v127
    v_add_f32 v106, v106, v128
    ds_write_b32 v129, v104 offset:256
    ds_write_b32 v129, v105 offset:384
    ds_read_b128 v[160:163], v130 offset:256
    ds_read_b128 v[176:179], v130 offset:384
    ds_read_b128 v[164:167], v130 offset:288
    ds_read_b128 v[180:183], v130 offset:416
    ds_read_b128 v[168:171], v130 offset:320
    ds_read_b128 v[184:187], v130 offset:448
    ds_read_b128 v[172:175], v130 offset:352
    ds_read_b128 v[188:191], v130 offset:480
    s_waitcnt lgkmcnt(10)
    v_add_f64 v[144:145], v[144:145], v[148:149]
    v_add_f64 v[146:147], v[146:147], v[150:151]
    s_nop 1
    v_mov_b32 v148, v144
    v_mov_b32 v149, v145
    v_mov_b32 v150, v146
    v_mov_b32 v151, v147
    s_nop 1
    v_permlane32_swap_b32 v144, v148
    v_permlane32_swap_b32 v145, v149
    v_permlane32_swap_b32 v146, v150
    v_permlane32_swap_b32 v147, v151
    s_nop 1
    v_add_f64 v[144:145], v[144:145], v[148:149]
    v_add_f64 v[146:147], v[146:147], v[150:151]
    v_ldexp_f64 v[144:145], v[144:145], -9
    v_ldexp_f64 v[146:147], v[146:147], -9
    v_fma_f64 v[146:147], -v[144:145], v[144:145], v[146:147]
    v_cvt_f32_f64 v140, v[144:145]
    v_cvt_f32_f64 v141, v[146:147]
    v_max_f32 v141, 0, v141
    v_add_f32 v141, 0x3727c5ac, v141
    v_rsq_f32 v141, v141
    s_nop 0
    v_mul_f32 v131, v140, v141
    v_sub_f32 v131, 0, v131
    ds_write_b32 v129, v141
    ds_write_b32 v129, v131 offset:128
    ds_read_b128 v[192:195], v130 offset:0
    ds_read_b128 v[208:211], v130 offset:128
    ds_read_b128 v[196:199], v130 offset:32
    ds_read_b128 v[212:215], v130 offset:160
    ds_read_b128 v[200:203], v130 offset:64
    ds_read_b128 v[216:219], v130 offset:192
    ds_read_b128 v[204:207], v130 offset:96
    ds_read_b128 v[220:223], v130 offset:224
    v_mul_f32 v132, 0x3eb8aa3b, v141
    v_mul_f32 v133, 0x3eb8aa3b, v131
    v_bfe_u32 v134, v108, 4, 1
    v_lshlrev_b32 v134, 16, v134
    v_and_b32 v135, 15, v108
    v_lshlrev_b32 v135, 4, v135
    v_lshlrev_b32 v136, 8, v125
    v_add3_u32 v134, v134, v135, v136
    v_lshrrev_b32 v135, 2, v108
    s_lshl_b32 s37, s28, 17
    s_lshl_b32 s38, s27, 10
    s_add_u32 s37, s37, s38
    s_add_u32 s39, s37, 4194304
    s_add_u32 s40, s37, 0
    s_add_u32 s41, s40, 65536
    s_add_u32 s42, s37, 2097152
    s_add_u32 s43, s42, 65536
    s_lshl_b32 s44, s28, 10
    s_lshl_b32 s45, s27, 3
    s_add_u32 s44, s44, s45
    s_add_u32 s44, s44, 6291456
    s_waitcnt lgkmcnt(10)
    v_mul_f32 v176, v176, v131
    v_mul_f32 v177, v177, v131
    v_mul_f32 v178, v178, v131
    v_mul_f32 v179, v179, v131
    v_mul_f32 v180, v180, v131
    v_mul_f32 v181, v181, v131
    v_mul_f32 v182, v182, v131
    v_mul_f32 v183, v183, v131
    v_mul_f32 v184, v184, v131
    v_mul_f32 v185, v185, v131
    v_mul_f32 v186, v186, v131
    v_mul_f32 v187, v187, v131
    v_mul_f32 v188, v188, v131
    v_mul_f32 v189, v189, v131
    v_mul_f32 v190, v190, v131
    v_mul_f32 v191, v191, v131
    v_fma_f32 v16, v16, v141, v176
    v_fma_f32 v17, v17, v141, v177
    v_fma_f32 v18, v18, v141, v178
    v_fma_f32 v19, v19, v141, v179
    v_fma_f32 v20, v20, v141, v180
    v_fma_f32 v21, v21, v141, v181
    v_fma_f32 v22, v22, v141, v182
    v_fma_f32 v23, v23, v141, v183
    v_fma_f32 v24, v24, v141, v184
    v_fma_f32 v25, v25, v141, v185
    v_fma_f32 v26, v26, v141, v186
    v_fma_f32 v27, v27, v141, v187
    v_fma_f32 v28, v28, v141, v188
    v_fma_f32 v29, v29, v141, v189
    v_fma_f32 v30, v30, v141, v190
    v_fma_f32 v31, v31, v141, v191
    v_mul_f32 v136, v16, v16
    v_mul_f32 v137, v24, v24
    v_fmac_f32 v136, v17, v17
    v_fmac_f32 v137, v25, v25
    v_fmac_f32 v136, v18, v18
    v_fmac_f32 v137, v26, v26
    v_fmac_f32 v136, v19, v19
    v_fmac_f32 v137, v27, v27
    v_fmac_f32 v136, v20, v20
    v_fmac_f32 v137, v28, v28
    v_fmac_f32 v136, v21, v21
    v_fmac_f32 v137, v29, v29
    v_fmac_f32 v136, v22, v22
    v_fmac_f32 v137, v30, v30
    v_fmac_f32 v136, v23, v23
    v_fmac_f32 v137, v31, v31
    v_mov_b32 v138, v136
    v_mov_b32 v139, v137
    v_cvt_pk_bf16_f32 v224, v16, v17
    v_cvt_pk_bf16_f32 v225, v18, v19
    v_cvt_pk_bf16_f32 v226, v20, v21
    v_cvt_pk_bf16_f32 v227, v22, v23
    v_cvt_pk_bf16_f32 v228, v24, v25
    v_cvt_pk_bf16_f32 v229, v26, v27
    v_cvt_pk_bf16_f32 v230, v28, v29
    v_cvt_pk_bf16_f32 v231, v30, v31
    v_permlane32_swap_b32 v136, v138
    v_permlane32_swap_b32 v137, v139
    buffer_store_dwordx4 v[224:227], v109, s[20:23], s42 offen sc1
    buffer_store_dwordx4 v[228:231], v109, s[20:23], s43 offen sc1
    v_add_f32 v136, v136, v138
    v_add_f32 v137, v137, v139
    v_mul_f32 v160, v160, v133
    v_mul_f32 v161, v161, v133
    v_mul_f32 v162, v162, v133
    v_mul_f32 v163, v163, v133
    v_max_f32_dpp v136, v136, v136 quad_perm:[1,0,3,2] row_mask:0xf bank_mask:0xf
    v_max_f32_dpp v137, v137, v137 quad_perm:[1,0,3,2] row_mask:0xf bank_mask:0xf
    v_mul_f32 v164, v164, v133
    v_mul_f32 v165, v165, v133
    v_mul_f32 v166, v166, v133
    v_mul_f32 v167, v167, v133
    v_max_f32_dpp v136, v136, v136 quad_perm:[2,3,0,1] row_mask:0xf bank_mask:0xf
    v_max_f32_dpp v137, v137, v137 quad_perm:[2,3,0,1] row_mask:0xf bank_mask:0xf
    v_mul_f32 v168, v168, v133
    v_mul_f32 v169, v169, v133
    v_mul_f32 v170, v170, v133
    v_mul_f32 v171, v171, v133
    v_max_f32_dpp v136, v136, v136 row_half_mirror row_mask:0xf bank_mask:0xf
    v_max_f32_dpp v137, v137, v137 row_half_mirror row_mask:0xf bank_mask:0xf
    v_mul_f32 v172, v172, v133
    v_mul_f32 v173, v173, v133
    v_mul_f32 v174, v174, v133
    v_mul_f32 v175, v175, v133
    v_max_f32_dpp v136, v136, v136 row_mirror row_mask:0xf bank_mask:0xf
    v_max_f32_dpp v137, v137, v137 row_mirror row_mask:0xf bank_mask:0xf
    v_fma_f32 v0, v0, v132, v160
    v_fma_f32 v1, v1, v132, v161
    v_fma_f32 v2, v2, v132, v162
    v_fma_f32 v3, v3, v132, v163
    v_fma_f32 v4, v4, v132, v164
    v_fma_f32 v5, v5, v132, v165
    v_fma_f32 v6, v6, v132, v166
    v_fma_f32 v7, v7, v132, v167
    v_fma_f32 v8, v8, v132, v168
    v_fma_f32 v9, v9, v132, v169
    v_fma_f32 v10, v10, v132, v170
    v_fma_f32 v11, v11, v132, v171
    v_fma_f32 v12, v12, v132, v172
    v_fma_f32 v13, v13, v132, v173
    v_fma_f32 v14, v14, v132, v174
    v_fma_f32 v15, v15, v132, v175
    v_cvt_pk_bf16_f32 v232, v0, v1
    v_cvt_pk_bf16_f32 v233, v2, v3
    v_cvt_pk_bf16_f32 v234, v4, v5
    v_cvt_pk_bf16_f32 v235, v6, v7
    v_cvt_pk_bf16_f32 v236, v8, v9
    v_cvt_pk_bf16_f32 v237, v10, v11
    v_cvt_pk_bf16_f32 v238, v12, v13
    v_cvt_pk_bf16_f32 v239, v14, v15
    buffer_store_dwordx4 v[232:235], v109, s[20:23], s40 offen sc1
    buffer_store_dwordx4 v[236:239], v109, s[20:23], s41 offen sc1
    s_waitcnt lgkmcnt(0)
    v_mul_f32 v208, v208, v106
    v_mul_f32 v209, v209, v106
    v_mul_f32 v210, v210, v106
    v_mul_f32 v211, v211, v106
    v_mul_f32 v212, v212, v106
    v_mul_f32 v213, v213, v106
    v_mul_f32 v214, v214, v106
    v_mul_f32 v215, v215, v106
    v_mul_f32 v216, v216, v106
    v_mul_f32 v217, v217, v106
    v_mul_f32 v218, v218, v106
    v_mul_f32 v219, v219, v106
    v_mul_f32 v220, v220, v106
    v_mul_f32 v221, v221, v106
    v_mul_f32 v222, v222, v106
    v_mul_f32 v223, v223, v106
    v_fma_f32 v32, v32, v192, v208
    v_fma_f32 v33, v33, v193, v209
    v_fma_f32 v34, v34, v194, v210
    v_fma_f32 v35, v35, v195, v211
    v_fma_f32 v36, v36, v196, v212
    v_fma_f32 v37, v37, v197, v213
    v_fma_f32 v38, v38, v198, v214
    v_fma_f32 v39, v39, v199, v215
    v_fma_f32 v40, v40, v200, v216
    v_fma_f32 v41, v41, v201, v217
    v_fma_f32 v42, v42, v202, v218
    v_fma_f32 v43, v43, v203, v219
    v_fma_f32 v44, v44, v204, v220
    v_fma_f32 v45, v45, v205, v221
    v_fma_f32 v46, v46, v206, v222
    v_fma_f32 v47, v47, v207, v223
    v_cvt_pk_bf16_f32 v240, v32, v33
    v_cvt_pk_bf16_f32 v241, v34, v35
    v_cvt_pk_bf16_f32 v242, v36, v37
    v_cvt_pk_bf16_f32 v243, v38, v39
    v_cvt_pk_bf16_f32 v244, v40, v41
    v_cvt_pk_bf16_f32 v245, v42, v43
    v_cvt_pk_bf16_f32 v246, v44, v45
    v_cvt_pk_bf16_f32 v247, v46, v47
    buffer_store_dwordx4 v[240:243], v134, s[20:23], s39 offen sc1
    buffer_store_dwordx4 v[244:247], v134, s[20:23], s39 offen offset:512 sc1
    s_mov_b64 exec, 0x10001
    buffer_store_dword v136, v135, s[20:23], s44 offen
    buffer_store_dword v137, v135, s[20:23], s44 offen offset:512
qkv1_kernel_end:
qkv1_kernel_end_real:
    s_endpgm
.globl attn1_kernel
.p2align 8
.type attn1_kernel,@function
attn1_kernel:
    s_mov_b32 s66, 1
    s_branch attn1_kernel_body
.globl attn2_kernel
.p2align 8
.type attn2_kernel,@function
attn2_kernel:
    s_mov_b32 s66, 0
attn1_kernel_body:
    s_cmp_ge_u32 s2, 256
    s_cbranch_scc1 attn1_kernel_end_real
    s_load_dwordx2 s[8:9], s[0:1], 72
    v_and_b32 v102, 63, v0
    v_lshrrev_b32 v104, 6, v0
    s_and_b32 s34, s2, 7
    s_lshr_b32 s35, s2, 3
    v_readfirstlane_b32 s26, v104
    v_lshlrev_b32 v103, 4, v102
    s_lshl_b32 s24, s34, 2
    s_and_b32 s36, s35, 3
    s_add_u32 s24, s24, s36
    s_lshr_b32 s25, s35, 2
    s_lshl_b32 s36, s24, 16
    s_mov_b32 s14, 41943040
    s_mov_b32 s15, 0x00020000
    s_and_b32 s70, s26, 7
    s_lshr_b32 s71, s26, 3
    s_lshl_b32 s27, s25, 3
    s_add_u32 s27, s27, s70
    s_and_b32 s39, s26, 1
    s_bfe_u32 s40, s26, 0x10001
    s_lshl_b32 s42, s40, 15
    s_lshl_b32 s43, s39, 16
    s_add_u32 s43, s43, s42
    s_lshl_b32 s44, s39, 21
    s_add_u32 s44, s44, s42
    s_add_u32 s44, s44, s36
    s_add_u32 s44, s44, 2097152
    s_mov_b32 s64, 0
    s_cmp_ge_u32 s26, 12
    s_cbranch_scc1 attn1_kernel_helper
    s_bfe_u32 s41, s26, 0x10002
    s_lshl_b32 s41, s41, 11
    s_add_u32 m0, s43, s41
    s_add_u32 s44, s44, s41
    s_waitcnt lgkmcnt(0)
    s_mov_b32 s12, s8
    s_and_b32 s13, s9, 0xffff
    s_cmp_ge_u32 s26, 8
    s_cbranch_scc1 attn1_kernel_pro
    buffer_load_dwordx4 v103, s[12:15], s44 offen offset:0 lds
    buffer_load_dwordx4 v103, s[12:15], s44 offen offset:1024 lds
    v_lshlrev_b32 v104, 2, v102
    v_add_u32 v104, 155648, v104
    v_mov_b32 v105, 0
    ds_write_b32 v104, v105
attn1_kernel_pro:
    s_setprio 3
    s_lshl_b32 s36, s24, 16
    s_lshl_b32 s37, s27, 10
    s_add_u32 s37, s37, s36
    s_lshl_b32 s38, s24, 9
    s_add_u32 s38, s38, 6291456
    v_lshlrev_b32 v105, 3, v102
    buffer_load_dwordx4 v[96:99], v103, s[12:15], s37 offen
    buffer_load_dwordx2 v[106:107], v105, s[12:15], s38 offen
    s_mov_b32 s73, 0
    s_mov_b32 s72, 4
    s_mov_b32 s68, 0xffff
    s_mov_b32 s69, 0xffff
    v_lshrrev_b32 v108, 5, v102
    v_lshlrev_b32 v108, 8, v108
    v_and_b32 v109, 15, v102
    v_lshlrev_b32 v109, 4, v109
    v_add_u32 v108, v108, v109
    v_add_u32 v112, 65536, v108
    s_lshl_b32 s45, s71, 15
    v_add_u32 v100, s45, v103
    v_add_u32 v101, s45, v112
    v_mov_b32 v80, 0
    v_mov_b32 v81, 0
    v_mov_b32 v82, 0
    v_mov_b32 v83, 0
    v_mov_b32 v84, 0
    v_mov_b32 v85, 0
    v_mov_b32 v86, 0
    v_mov_b32 v87, 0
    v_mov_b32 v88, 0
    v_mov_b32 v89, 0
    v_mov_b32 v90, 0
    v_mov_b32 v91, 0
    v_mov_b32 v92, 0
    v_mov_b32 v93, 0
    v_mov_b32 v94, 0
    v_mov_b32 v95, 0
    s_mov_b32 exec_lo, 0x110000
    s_mov_b32 exec_hi, 0x110000
    v_mov_b32 v80, 0x3f803f80
    v_mov_b32 v81, 0x3f803f80
    v_mov_b32 v82, 0x3f803f80
    v_mov_b32 v83, 0x3f803f80
    v_mov_b32 v84, 0x3f803f80
    v_mov_b32 v85, 0x3f803f80
    v_mov_b32 v86, 0x3f803f80
    v_mov_b32 v87, 0x3f803f80
    v_mov_b32 v88, 0x3f803f80
    v_mov_b32 v89, 0x3f803f80
    v_mov_b32 v90, 0x3f803f80
    v_mov_b32 v91, 0x3f803f80
    v_mov_b32 v92, 0x3f803f80
    v_mov_b32 v93, 0x3f803f80
    v_mov_b32 v94, 0x3f803f80
    v_mov_b32 v95, 0x3f803f80
    s_mov_b64 exec, -1
    v_mov_b32 v110, 0
    v_mov_b32 v118, 155648
    s_waitcnt vmcnt(0) lgkmcnt(0)
    v_max_f32 v106, v106, v107
    v_dot2c_f32_bf16 v110, v96, v96
    v_dot2c_f32_bf16 v110, v97, v97
    v_dot2c_f32_bf16 v110, v98, v98
    v_dot2c_f32_bf16 v110, v99, v99
    s_nop 1
    v_max_f32_dpp v106, v106, v106 quad_perm:[1,0,3,2] row_mask:0xf bank_mask:0xf
    s_nop 1
    v_max_f32_dpp v106, v106, v106 quad_perm:[2,3,0,1] row_mask:0xf bank_mask:0xf
    s_nop 1
    v_max_f32_dpp v106, v106, v106 row_half_mirror row_mask:0xf bank_mask:0xf
    s_nop 1
    v_max_f32_dpp v106, v106, v106 row_mirror row_mask:0xf bank_mask:0xf
    v_mov_b32 v111, v110
    s_nop 1
    v_permlane32_swap_b32 v110, v111
    v_readlane_b32 s46, v106, 0
    v_readlane_b32 s47, v106, 16
    v_readlane_b32 s48, v106, 32
    v_readlane_b32 s49, v106, 48
    v_add_f32 v110, v110, v111
    s_max_u32 s46, s46, s47
    s_max_u32 s48, s48, s49
    s_max_u32 s46, s46, s48
    s_nop 1
    v_mul_f32 v110, s46, v110
    v_sqrt_f32 v110, v110
    s_nop 0
    v_mul_f32 v110, 0xbf810000, v110
    s_cmp_lg_u32 s64, 0
    s_cbranch_scc1 attn1_kernel_main
    s_barrier
attn1_kernel_main:
    ds_read_b128 v[72:75], v100
    ds_read_b128 v[76:79], v100 offset:1024
    s_mov_b64 exec, s[68:69]
    ds_read_b128 v[80:83], v101
    ds_read_b128 v[84:87], v101 offset:512
    s_mov_b64 exec, -1
    s_mov_b32 s65, 0
    v_mov_b32 v16, v110
    v_mov_b32 v17, v110
    v_mov_b32 v18, v110
    v_mov_b32 v19, v110
    v_mov_b32 v20, v110
    v_mov_b32 v21, v110
    v_mov_b32 v22, v110
    v_mov_b32 v23, v110
    v_mov_b32 v24, v110
    v_mov_b32 v25, v110
    v_mov_b32 v26, v110
    v_mov_b32 v27, v110
    v_mov_b32 v28, v110
    v_mov_b32 v29, v110
    v_mov_b32 v30, v110
    v_mov_b32 v31, v110
    v_mov_b32 v0, 0
    v_mov_b32 v1, 0
    v_mov_b32 v2, 0
    v_mov_b32 v3, 0
    v_mov_b32 v4, 0
    v_mov_b32 v5, 0
    v_mov_b32 v6, 0
    v_mov_b32 v7, 0
    v_mov_b32 v8, 0
    v_mov_b32 v9, 0
    v_mov_b32 v10, 0
    v_mov_b32 v11, 0
    v_mov_b32 v12, 0
    v_mov_b32 v13, 0
    v_mov_b32 v14, 0
    v_mov_b32 v15, 0
    v_mov_b32 v68, 0
    v_mov_b32 v69, 0
    v_mov_b32 v70, 0
    v_mov_b32 v71, 0
    s_waitcnt lgkmcnt(3)
    v_mfma_f32_32x32x16_bf16 v[32:47], v[72:75], v[96:99], v[16:31]
    s_nop 9
attn1_kernel_loop:
    s_cmp_lg_u32 s65, 3
    s_cbranch_scc1 attn1_kernel_pr3_0
    s_setprio 1
attn1_kernel_pr3_0:
    s_waitcnt lgkmcnt(2)
    v_mfma_f32_32x32x16_bf16 v[48:63], v[76:79], v[96:99], v[16:31]
    ds_read_b128 v[72:75], v100 offset:2048
    v_exp_f32 v32, v32
    v_exp_f32 v33, v33
    v_exp_f32 v34, v34
    v_exp_f32 v35, v35
    v_exp_f32 v36, v36
    v_exp_f32 v37, v37
    v_exp_f32 v38, v38
    v_exp_f32 v39, v39
    v_mfma_f32_32x32x16_bf16 v[0:15], v[92:95], v[68:71], v[0:15]
    s_mov_b64 exec, s[68:69]
    ds_read_b128 v[88:91], v101 offset:1024
    ds_read_b128 v[92:95], v101 offset:1536
    s_mov_b64 exec, -1
    v_cvt_pk_bf16_f32 v64, v32, v33
    v_cvt_pk_bf16_f32 v65, v34, v35
    v_cvt_pk_bf16_f32 v66, v36, v37
    v_cvt_pk_bf16_f32 v67, v38, v39
    v_exp_f32 v40, v40
    v_exp_f32 v41, v41
    v_exp_f32 v42, v42
    v_exp_f32 v43, v43
    s_waitcnt lgkmcnt(4)
    v_mfma_f32_32x32x16_bf16 v[0:15], v[80:83], v[64:67], v[0:15]
    v_exp_f32 v44, v44
    v_exp_f32 v45, v45
    v_exp_f32 v46, v46
    v_exp_f32 v47, v47
    v_cvt_pk_bf16_f32 v68, v40, v41
    v_cvt_pk_bf16_f32 v69, v42, v43
    v_cvt_pk_bf16_f32 v70, v44, v45
    v_cvt_pk_bf16_f32 v71, v46, v47
    s_waitcnt lgkmcnt(2)
    v_mfma_f32_32x32x16_bf16 v[32:47], v[72:75], v[96:99], v[16:31]
    ds_read_b128 v[76:79], v100 offset:3072
    v_exp_f32 v48, v48
    v_exp_f32 v49, v49
    v_exp_f32 v50, v50
    v_exp_f32 v51, v51
    v_exp_f32 v52, v52
    v_exp_f32 v53, v53
    v_exp_f32 v54, v54
    v_exp_f32 v55, v55
    v_mfma_f32_32x32x16_bf16 v[0:15], v[84:87], v[68:71], v[0:15]
    s_mov_b64 exec, s[68:69]
    ds_read_b128 v[80:83], v101 offset:2048
    ds_read_b128 v[84:87], v101 offset:2560
    s_mov_b64 exec, -1
    v_cvt_pk_bf16_f32 v64, v48, v49
    v_cvt_pk_bf16_f32 v65, v50, v51
    v_cvt_pk_bf16_f32 v66, v52, v53
    v_cvt_pk_bf16_f32 v67, v54, v55
    v_exp_f32 v56, v56
    v_exp_f32 v57, v57
    v_exp_f32 v58, v58
    v_exp_f32 v59, v59
    s_waitcnt lgkmcnt(4)
    v_mfma_f32_32x32x16_bf16 v[0:15], v[88:91], v[64:67], v[0:15]
    v_exp_f32 v60, v60
    v_exp_f32 v61, v61
    v_exp_f32 v62, v62
    v_exp_f32 v63, v63
    v_cvt_pk_bf16_f32 v68, v56, v57
    v_cvt_pk_bf16_f32 v69, v58, v59
    v_cvt_pk_bf16_f32 v70, v60, v61
    v_cvt_pk_bf16_f32 v71, v62, v63
    s_cmp_ge_u32 s65, 2
    s_cbranch_scc1 attn1_kernel_nopoll
    s_lshl_b32 s50, s65, 2
    s_add_u32 s50, s50, 4
attn1_kernel_spoll:
    ds_read_b32 v119, v118 offset:64
    s_waitcnt lgkmcnt(0)
    v_readfirstlane_b32 s51, v119
    s_nop 3
    s_cmp_lt_u32 s51, s50
    s_cbranch_scc1 attn1_kernel_spoll
attn1_kernel_nopoll:
    s_waitcnt lgkmcnt(2)
    v_mfma_f32_32x32x16_bf16 v[48:63], v[76:79], v[96:99], v[16:31]
    ds_read_b128 v[72:75], v100 offset:4096
    v_exp_f32 v32, v32
    v_exp_f32 v33, v33
    v_exp_f32 v34, v34
    v_exp_f32 v35, v35
    v_exp_f32 v36, v36
    v_exp_f32 v37, v37
    v_exp_f32 v38, v38
    v_exp_f32 v39, v39
    v_mfma_f32_32x32x16_bf16 v[0:15], v[92:95], v[68:71], v[0:15]
    s_mov_b64 exec, s[68:69]
    ds_read_b128 v[88:91], v101 offset:3072
    ds_read_b128 v[92:95], v101 offset:3584
    s_mov_b64 exec, -1
    v_cvt_pk_bf16_f32 v64, v32, v33
    v_cvt_pk_bf16_f32 v65, v34, v35
    v_cvt_pk_bf16_f32 v66, v36, v37
    v_cvt_pk_bf16_f32 v67, v38, v39
    v_exp_f32 v40, v40
    v_exp_f32 v41, v41
    v_exp_f32 v42, v42
    v_exp_f32 v43, v43
    s_waitcnt lgkmcnt(4)
    v_mfma_f32_32x32x16_bf16 v[0:15], v[80:83], v[64:67], v[0:15]
    v_exp_f32 v44, v44
    v_exp_f32 v45, v45
    v_exp_f32 v46, v46
    v_exp_f32 v47, v47
    v_cvt_pk_bf16_f32 v68, v40, v41
    v_cvt_pk_bf16_f32 v69, v42, v43
    v_cvt_pk_bf16_f32 v70, v44, v45
    v_cvt_pk_bf16_f32 v71, v46, v47
    s_waitcnt lgkmcnt(2)
    v_mfma_f32_32x32x16_bf16 v[32:47], v[72:75], v[96:99], v[16:31]
    ds_read_b128 v[76:79], v100 offset:5120
    v_exp_f32 v48, v48
    v_exp_f32 v49, v49
    v_exp_f32 v50, v50
    v_exp_f32 v51, v51
    v_exp_f32 v52, v52
    v_exp_f32 v53, v53
    v_exp_f32 v54, v54
    v_exp_f32 v55, v55
    v_mfma_f32_32x32x16_bf16 v[0:15], v[84:87], v[68:71], v[0:15]
    s_mov_b64 exec, s[68:69]
    ds_read_b128 v[80:83], v101 offset:4096
    ds_read_b128 v[84:87], v101 offset:4608
    s_mov_b64 exec, -1
    v_cvt_pk_bf16_f32 v64, v48, v49
    v_cvt_pk_bf16_f32 v65, v50, v51
    v_cvt_pk_bf16_f32 v66, v52, v53
    v_cvt_pk_bf16_f32 v67, v54, v55
    v_exp_f32 v56, v56
    v_exp_f32 v57, v57
    v_exp_f32 v58, v58
    v_exp_f32 v59, v59
    s_waitcnt lgkmcnt(4)
    v_mfma_f32_32x32x16_bf16 v[0:15], v[88:91], v[64:67], v[0:15]
    v_exp_f32 v60, v60
    v_exp_f32 v61, v61
    v_exp_f32 v62, v62
    v_exp_f32 v63, v63
    v_cvt_pk_bf16_f32 v68, v56, v57
    v_cvt_pk_bf16_f32 v69, v58, v59
    v_cvt_pk_bf16_f32 v70, v60, v61
    v_cvt_pk_bf16_f32 v71, v62, v63
    s_cmp_lg_u32 s65, 1
    s_cbranch_scc1 attn1_kernel_pr1_4
    s_setprio 2
attn1_kernel_pr1_4:
    s_waitcnt lgkmcnt(2)
    v_mfma_f32_32x32x16_bf16 v[48:63], v[76:79], v[96:99], v[16:31]
    ds_read_b128 v[72:75], v100 offset:6144
    v_exp_f32 v32, v32
    v_exp_f32 v33, v33
    v_exp_f32 v34, v34
    v_exp_f32 v35, v35
    v_exp_f32 v36, v36
    v_exp_f32 v37, v37
    v_exp_f32 v38, v38
    v_exp_f32 v39, v39
    v_mfma_f32_32x32x16_bf16 v[0:15], v[92:95], v[68:71], v[0:15]
    s_mov_b64 exec, s[68:69]
    ds_read_b128 v[88:91], v101 offset:5120
    ds_read_b128 v[92:95], v101 offset:5632
    s_mov_b64 exec, -1
    v_cvt_pk_bf16_f32 v64, v32, v33
    v_cvt_pk_bf16_f32 v65, v34, v35
    v_cvt_pk_bf16_f32 v66, v36, v37
    v_cvt_pk_bf16_f32 v67, v38, v39
    v_exp_f32 v40, v40
    v_exp_f32 v41, v41
    v_exp_f32 v42, v42
    v_exp_f32 v43, v43
    s_waitcnt lgkmcnt(4)
    v_mfma_f32_32x32x16_bf16 v[0:15], v[80:83], v[64:67], v[0:15]
    v_exp_f32 v44, v44
    v_exp_f32 v45, v45
    v_exp_f32 v46, v46
    v_exp_f32 v47, v47
    v_cvt_pk_bf16_f32 v68, v40, v41
    v_cvt_pk_bf16_f32 v69, v42, v43
    v_cvt_pk_bf16_f32 v70, v44, v45
    v_cvt_pk_bf16_f32 v71, v46, v47
    s_lshl_b32 s50, s65, 4
    s_add_u32 s50, s50, s26
    s_sub_u32 s50, s50, 32
    s_cmp_ge_u32 s50, 6
    s_cbranch_scc1 attn1_kernel_nowpf
    s_and_b32 s50, s2, 7
    s_lshr_b32 s51, s2, 3
    s_lshl_b32 s52, s51, 14
    s_add_u32 s52, s52, 24641536
    s_lshl_b32 s53, s26, 13
    s_add_u32 s52, s52, s53
    s_lshr_b32 s54, s50, 1
    s_mul_i32 s54, s54, 917504
    s_mul_i32 s55, s51, 28672
    s_add_u32 s54, s54, s55
    s_add_u32 s54, s54, s53
    s_add_u32 s54, s54, 29343744
    s_cmp_ge_u32 s26, 2
    s_cselect_b32 s52, s54, s52
    s_mul_i32 s54, s51, 57344
    s_add_u32 s54, s54, s53
    s_add_u32 s54, s54, 33505280
    s_cmp_ge_u32 s26, 6
    s_cselect_b32 s52, s54, s52
    s_lshr_b32 s54, s50, 2
    s_mul_i32 s54, s54, 786432
    s_mul_i32 s55, s51, 24576
    s_add_u32 s54, s54, s55
    s_add_u32 s54, s54, s53
    s_add_u32 s54, s54, 27156480
    s_cmp_ge_u32 s26, 13
    s_cselect_b32 s52, s54, s52
    v_lshlrev_b32 v120, 7, v102
    buffer_load_dword v121, v120, s[12:15], s52 offen
attn1_kernel_nowpf:
    s_waitcnt lgkmcnt(2)
    v_mfma_f32_32x32x16_bf16 v[32:47], v[72:75], v[96:99], v[16:31]
    ds_read_b128 v[76:79], v100 offset:7168
    v_exp_f32 v48, v48
    v_exp_f32 v49, v49
    v_exp_f32 v50, v50
    v_exp_f32 v51, v51
    v_exp_f32 v52, v52
    v_exp_f32 v53, v53
    v_exp_f32 v54, v54
    v_exp_f32 v55, v55
    v_mfma_f32_32x32x16_bf16 v[0:15], v[84:87], v[68:71], v[0:15]
    s_mov_b64 exec, s[68:69]
    ds_read_b128 v[80:83], v101 offset:6144
    ds_read_b128 v[84:87], v101 offset:6656
    s_mov_b64 exec, -1
    v_cvt_pk_bf16_f32 v64, v48, v49
    v_cvt_pk_bf16_f32 v65, v50, v51
    v_cvt_pk_bf16_f32 v66, v52, v53
    v_cvt_pk_bf16_f32 v67, v54, v55
    v_exp_f32 v56, v56
    v_exp_f32 v57, v57
    v_exp_f32 v58, v58
    v_exp_f32 v59, v59
    s_waitcnt lgkmcnt(4)
    v_mfma_f32_32x32x16_bf16 v[0:15], v[88:91], v[64:67], v[0:15]
    v_exp_f32 v60, v60
    v_exp_f32 v61, v61
    v_exp_f32 v62, v62
    v_exp_f32 v63, v63
    v_cvt_pk_bf16_f32 v68, v56, v57
    v_cvt_pk_bf16_f32 v69, v58, v59
    v_cvt_pk_bf16_f32 v70, v60, v61
    v_cvt_pk_bf16_f32 v71, v62, v63
    s_cmp_lg_u32 s65, 3
    s_cbranch_scc1 attn1_kernel_pr3_6
    s_setprio 0
attn1_kernel_pr3_6:
    s_waitcnt lgkmcnt(2)
    v_mfma_f32_32x32x16_bf16 v[48:63], v[76:79], v[96:99], v[16:31]
    ds_read_b128 v[72:75], v100 offset:8192
    v_exp_f32 v32, v32
    v_exp_f32 v33, v33
    v_exp_f32 v34, v34
    v_exp_f32 v35, v35
    v_exp_f32 v36, v36
    v_exp_f32 v37, v37
    v_exp_f32 v38, v38
    v_exp_f32 v39, v39
    v_mfma_f32_32x32x16_bf16 v[0:15], v[92:95], v[68:71], v[0:15]
    s_mov_b64 exec, s[68:69]
    ds_read_b128 v[88:91], v101 offset:7168
    ds_read_b128 v[92:95], v101 offset:7680
    s_mov_b64 exec, -1
    v_cvt_pk_bf16_f32 v64, v32, v33
    v_cvt_pk_bf16_f32 v65, v34, v35
    v_cvt_pk_bf16_f32 v66, v36, v37
    v_cvt_pk_bf16_f32 v67, v38, v39
    v_exp_f32 v40, v40
    v_exp_f32 v41, v41
    v_exp_f32 v42, v42
    v_exp_f32 v43, v43
    s_waitcnt lgkmcnt(4)
    v_mfma_f32_32x32x16_bf16 v[0:15], v[80:83], v[64:67], v[0:15]
    v_exp_f32 v44, v44
    v_exp_f32 v45, v45
    v_exp_f32 v46, v46
    v_exp_f32 v47, v47
    v_cvt_pk_bf16_f32 v68, v40, v41
    v_cvt_pk_bf16_f32 v69, v42, v43
    v_cvt_pk_bf16_f32 v70, v44, v45
    v_cvt_pk_bf16_f32 v71, v46, v47
    s_waitcnt lgkmcnt(2)
    v_mfma_f32_32x32x16_bf16 v[32:47], v[72:75], v[96:99], v[16:31]
    ds_read_b128 v[76:79], v100 offset:9216
    v_exp_f32 v48, v48
    v_exp_f32 v49, v49
    v_exp_f32 v50, v50
    v_exp_f32 v51, v51
    v_exp_f32 v52, v52
    v_exp_f32 v53, v53
    v_exp_f32 v54, v54
    v_exp_f32 v55, v55
    v_mfma_f32_32x32x16_bf16 v[0:15], v[84:87], v[68:71], v[0:15]
    s_mov_b64 exec, s[68:69]
    ds_read_b128 v[80:83], v101 offset:8192
    ds_read_b128 v[84:87], v101 offset:8704
    s_mov_b64 exec, -1
    v_cvt_pk_bf16_f32 v64, v48, v49
    v_cvt_pk_bf16_f32 v65, v50, v51
    v_cvt_pk_bf16_f32 v66, v52, v53
    v_cvt_pk_bf16_f32 v67, v54, v55
    v_exp_f32 v56, v56
    v_exp_f32 v57, v57
    v_exp_f32 v58, v58
    v_exp_f32 v59, v59
    s_waitcnt lgkmcnt(4)
    v_mfma_f32_32x32x16_bf16 v[0:15], v[88:91], v[64:67], v[0:15]
    v_exp_f32 v60, v60
    v_exp_f32 v61, v61
    v_exp_f32 v62, v62
    v_exp_f32 v63, v63
    v_add_u32 v100, 8192, v100
    v_add_u32 v101, 8192, v101
    s_add_u32 s65, s65, 1
    s_cmp_lt_u32 s65, s72
    v_cvt_pk_bf16_f32 v68, v56, v57
    v_cvt_pk_bf16_f32 v69, v58, v59
    v_cvt_pk_bf16_f32 v70, v60, v61
    v_cvt_pk_bf16_f32 v71, v62, v63
    s_cbranch_scc1 attn1_kernel_loop
    s_waitcnt lgkmcnt(0)
    v_mfma_f32_32x32x16_bf16 v[0:15], v[92:95], v[68:71], v[0:15]
    s_lshl_b32 s36, s27, 15
    s_lshl_b32 s37, s24, 10
    s_add_u32 s36, s36, s37
    s_add_u32 s36, s36, 8388608
    s_mov_b32 s37, 0x2b800000
    s_cmp_lg_u32 s73, 0
    s_cbranch_scc1 attn1_kernel_fin0
    s_lshl_b32 s38, s70, 3
    s_add_u32 s38, s38, 155648
    v_mov_b32 v113, s38
    v_mov_b32 v114, 1
    s_mul_i32 s39, s70, 2304
    s_add_u32 s39, s39, 131072
    s_mov_b64 exec, 1
    ds_add_rtn_u32 v115, v113, v114
    s_mov_b64 exec, -1
    v_add_u32 v116, s39, v103
    v_lshlrev_b32 v117, 2, v102
    v_add_u32 v117, s39, v117
    s_waitcnt lgkmcnt(0)
    v_readfirstlane_b32 s40, v115
    s_nop 3
    s_cmp_lg_u32 s40, 0
    s_cbranch_scc1 attn1_kernel_second
attn1_kernel_sdpoll:
    ds_read_b32 v119, v118 offset:68
    s_waitcnt lgkmcnt(0)
    v_readfirstlane_b32 s51, v119
    s_nop 3
    s_cmp_lt_u32 s51, 4
    s_cbranch_scc1 attn1_kernel_sdpoll
    ds_write_b128 v116, v[0:3]
    ds_write_b128 v116, v[4:7] offset:1024
    ds_write_b32 v117, v8 offset:2048
    s_waitcnt lgkmcnt(0)
    ds_write_b32 v113, v114 offset:4
    s_branch attn1_kernel_end
attn1_kernel_second:
attn1_kernel_poll:
    ds_read_b32 v115, v113 offset:4
    s_waitcnt lgkmcnt(0)
    v_readfirstlane_b32 s40, v115
    s_nop 3
    s_cmp_eq_u32 s40, 0
    s_cbranch_scc1 attn1_kernel_poll
    ds_read_b128 v[32:35], v116
    ds_read_b128 v[36:39], v116 offset:1024
    ds_read_b32 v40, v117 offset:2048
    s_waitcnt lgkmcnt(0)
    v_add_f32 v0, v0, v32
    v_add_f32 v1, v1, v33
    v_add_f32 v2, v2, v34
    v_add_f32 v3, v3, v35
    v_add_f32 v4, v4, v36
    v_add_f32 v5, v5, v37
    v_add_f32 v6, v6, v38
    v_add_f32 v7, v7, v39
    v_add_f32 v8, v8, v40
    v_cmp_nge_f32 vcc, v8, s37
    s_nop 4
    s_cbranch_vccnz attn1_kernel_fallback
attn1_kernel_fin0:
    s_nop 6
    v_rcp_f32 v9, v8
    s_nop 0
    v_mul_f32 v0, v0, v9
    v_mul_f32 v1, v1, v9
    v_mul_f32 v2, v2, v9
    v_mul_f32 v3, v3, v9
    v_mul_f32 v4, v4, v9
    v_mul_f32 v5, v5, v9
    v_mul_f32 v6, v6, v9
    v_mul_f32 v7, v7, v9
    v_cvt_pk_bf16_f32 v64, v0, v1
    v_cvt_pk_bf16_f32 v65, v2, v3
    v_cvt_pk_bf16_f32 v66, v4, v5
    v_cvt_pk_bf16_f32 v67, v6, v7
    buffer_store_dwordx4 v[64:67], v103, s[12:15], s36 offen sc1
attn1_kernel_end:
attn1_kernel_end_real:
    s_endpgm
attn1_kernel_fallback:
    s_mov_b32 s73, 1
    s_mov_b32 s64, 1
    s_mov_b32 s72, 8
    v_mov_b32 v113, 0xff800000
    v_mov_b32 v114, v103
    s_mov_b32 s38, 0
attn1_kernel_fbloop:
    ds_read_b128 v[72:75], v114
    v_add_u32 v114, 1024, v114
    s_waitcnt lgkmcnt(0)
    v_mfma_f32_32x32x16_bf16 v[32:47], v[72:75], v[96:99], 0
    s_nop 15
    s_nop 3
    v_max3_f32 v113, v32, v33, v113
    v_max3_f32 v113, v34, v35, v113
    v_max3_f32 v113, v36, v37, v113
    v_max3_f32 v113, v38, v39, v113
    v_max3_f32 v113, v40, v41, v113
    v_max3_f32 v113, v42, v43, v113
    v_max3_f32 v113, v44, v45, v113
    v_max3_f32 v113, v46, v47, v113
    s_add_u32 s38, s38, 1
    s_cmp_lt_u32 s38, 64
    s_cbranch_scc1 attn1_kernel_fbloop
    v_mov_b32 v114, v113
    s_nop 1
    v_permlane32_swap_b32 v113, v114
    s_nop 1
    v_max_f32 v113, v113, v114
    v_sub_f32 v110, 0, v113
    v_mov_b32 v100, v103
    v_mov_b32 v101, v112
    v_mov_b32 v80, 0
    v_mov_b32 v81, 0
    v_mov_b32 v82, 0
    v_mov_b32 v83, 0
    v_mov_b32 v84, 0
    v_mov_b32 v85, 0
    v_mov_b32 v86, 0
    v_mov_b32 v87, 0
    v_mov_b32 v88, 0
    v_mov_b32 v89, 0
    v_mov_b32 v90, 0
    v_mov_b32 v91, 0
    v_mov_b32 v92, 0
    v_mov_b32 v93, 0
    v_mov_b32 v94, 0
    v_mov_b32 v95, 0
    s_mov_b32 exec_lo, 0x110000
    s_mov_b32 exec_hi, 0x110000
    v_mov_b32 v80, 0x3f803f80
    v_mov_b32 v81, 0x3f803f80
    v_mov_b32 v82, 0x3f803f80
    v_mov_b32 v83, 0x3f803f80
    v_mov_b32 v84, 0x3f803f80
    v_mov_b32 v85, 0x3f803f80
    v_mov_b32 v86, 0x3f803f80
    v_mov_b32 v87, 0x3f803f80
    v_mov_b32 v88, 0x3f803f80
    v_mov_b32 v89, 0x3f803f80
    v_mov_b32 v90, 0x3f803f80
    v_mov_b32 v91, 0x3f803f80
    v_mov_b32 v92, 0x3f803f80
    v_mov_b32 v93, 0x3f803f80
    v_mov_b32 v94, 0x3f803f80
    v_mov_b32 v95, 0x3f803f80
    s_mov_b64 exec, -1
    s_branch attn1_kernel_main
attn1_kernel_helper:
    s_load_dwordx2 s[6:7], s[0:1], 8
    s_load_dwordx4 s[28:31], s[0:1], 32
    s_load_dwordx2 s[60:61], s[0:1], 16
    s_load_dwordx2 s[62:63], s[0:1], 48
    s_add_u32 s43, s43, 4096
    s_add_u32 s44, s44, 4096
    s_mov_b32 s64, 1
    s_setprio 3
    v_mov_b32 v118, 155648
    v_mov_b32 v119, 1
    s_waitcnt lgkmcnt(0)
    s_mov_b32 s12, s8
    s_and_b32 s13, s9, 0xffff
    s_mov_b32 m0, s43
    s_add_u32 s43, s43, 4096
    buffer_load_dwordx4 v103, s[12:15], s44 offen offset:0 lds
    buffer_load_dwordx4 v103, s[12:15], s44 offen offset:1024 lds
    buffer_load_dwordx4 v103, s[12:15], s44 offen offset:2048 lds
    buffer_load_dwordx4 v103, s[12:15], s44 offen offset:3072 lds
    s_add_u32 s44, s44, 4096
    s_mov_b32 m0, s43
    s_add_u32 s43, s43, 4096
    buffer_load_dwordx4 v103, s[12:15], s44 offen offset:0 lds
    buffer_load_dwordx4 v103, s[12:15], s44 offen offset:1024 lds
    buffer_load_dwordx4 v103, s[12:15], s44 offen offset:2048 lds
    buffer_load_dwordx4 v103, s[12:15], s44 offen offset:3072 lds
    s_add_u32 s44, s44, 4096
    s_barrier
    s_mov_b32 m0, s43
    s_add_u32 s43, s43, 4096
    buffer_load_dwordx4 v103, s[12:15], s44 offen offset:0 lds
    buffer_load_dwordx4 v103, s[12:15], s44 offen offset:1024 lds
    buffer_load_dwordx4 v103, s[12:15], s44 offen offset:2048 lds
    buffer_load_dwordx4 v103, s[12:15], s44 offen offset:3072 lds
    s_add_u32 s44, s44, 4096
    s_mov_b32 m0, s43
    s_add_u32 s43, s43, 4096
    buffer_load_dwordx4 v103, s[12:15], s44 offen offset:0 lds
    buffer_load_dwordx4 v103, s[12:15], s44 offen offset:1024 lds
    buffer_load_dwordx4 v103, s[12:15], s44 offen offset:2048 lds
    buffer_load_dwordx4 v103, s[12:15], s44 offen offset:3072 lds
    s_add_u32 s44, s44, 4096
    s_waitcnt vmcnt(8)
    s_mov_b64 exec, 1
    ds_add_u32 v118, v119 offset:64
    s_mov_b64 exec, -1
    s_mov_b32 m0, s43
    s_add_u32 s43, s43, 4096
    buffer_load_dwordx4 v103, s[12:15], s44 offen offset:0 lds
    buffer_load_dwordx4 v103, s[12:15], s44 offen offset:1024 lds
    buffer_load_dwordx4 v103, s[12:15], s44 offen offset:2048 lds
    buffer_load_dwordx4 v103, s[12:15], s44 offen offset:3072 lds
    s_add_u32 s44, s44, 4096
    s_mov_b32 m0, s43
    s_add_u32 s43, s43, 4096
    buffer_load_dwordx4 v103, s[12:15], s44 offen offset:0 lds
    buffer_load_dwordx4 v103, s[12:15], s44 offen offset:1024 lds
    buffer_load_dwordx4 v103, s[12:15], s44 offen offset:2048 lds
    buffer_load_dwordx4 v103, s[12:15], s44 offen offset:3072 lds
    s_add_u32 s44, s44, 4096
    s_mov_b32 m0, s43
    s_add_u32 s43, s43, 4096
    buffer_load_dwordx4 v103, s[12:15], s44 offen offset:0 lds
    buffer_load_dwordx4 v103, s[12:15], s44 offen offset:1024 lds
    buffer_load_dwordx4 v103, s[12:15], s44 offen offset:2048 lds
    buffer_load_dwordx4 v103, s[12:15], s44 offen offset:3072 lds
    s_add_u32 s44, s44, 4096
    s_waitcnt vmcnt(0)
    s_mov_b64 exec, 1
    ds_add_u32 v118, v119 offset:64
    s_mov_b64 exec, -1
    s_cmp_eq_u32 s66, 0
    s_cbranch_scc1 attn1_kernel_hdone
    s_sub_u32 s45, s26, 12
    s_lshl_b32 s34, s45, 13
    s_add_u32 s34, s34, 131072
    s_lshl_b32 s67, s45, 8
    s_add_u32 s67, s67, s2
    s_mov_b32 s33, 0x3f803f80
    s_cmp_ge_u32 s67, 768
    s_cbranch_scc1 attn1_kernel_hdone
attn1_kernel_wloop:
    v_lshrrev_b32 v104, 3, v102
    v_and_b32 v105, 7, v102
    v_bfe_u32 v106, v102, 4, 1
    v_lshlrev_b32 v106, 2, v106
    v_xor_b32 v105, v105, v106
    v_lshlrev_b32 v105, 4, v105
    v_lshrrev_b32 v107, 5, v102
    v_lshlrev_b32 v107, 2, v107
    v_bfe_u32 v108, v102, 2, 2
    v_add_u32 v107, v107, v108
    v_lshlrev_b32 v107, 7, v107
    v_and_b32 v109, 3, v102
    v_lshlrev_b32 v109, 3, v109
    v_bfe_u32 v110, v102, 3, 1
    v_lshlrev_b32 v110, 6, v110
    v_bfe_u32 v108, v102, 4, 1
    v_add3_u32 v107, v107, v109, s34
    s_cmp_lt_u32 s67, 448
    s_cbranch_scc1 attn1_kernel_w_gu
    s_cmp_lt_u32 s67, 640
    s_cbranch_scc1 attn1_kernel_w_q
    s_mov_b32 s18, 1835008
    s_mov_b32 s42, 704
    s_mov_b32 s43, 229376
    s_mov_b32 s44, 33554432
    s_cmp_lt_u32 s67, 704
    s_cselect_b32 s16, s60, s62
    s_cselect_b32 s17, s61, s63
    s_cselect_b32 s18, 524288, s18
    s_cselect_b32 s42, 640, s42
    s_cselect_b32 s43, 65536, s43
    s_cselect_b32 s44, 24641536, s44
    s_and_b32 s17, s17, 0xffff
    s_mov_b32 s19, 0x00020000
    s_sub_u32 s42, s67, s42
    s_lshr_b32 s35, s42, 3
    s_and_b32 s36, s42, 7
    s_mov_b32 s45, 1024
    s_mul_i32 s40, s36, s43
    s_lshl_b32 s41, s35, 13
    s_add_u32 s40, s40, s41
    s_add_u32 s40, s40, s44
    s_mov_b32 s46, 1024
    s_mov_b32 s47, 2048
    s_mov_b32 s48, 35651584
    s_branch attn1_kernel_w_go
attn1_kernel_w_q:
    s_mov_b32 s16, s6
    s_and_b32 s17, s7, 0xffff
    s_mov_b32 s18, 1572864
    s_mov_b32 s19, 0x00020000
    s_sub_u32 s42, s67, 448
    s_mul_i32 s35, s42, 2731
    s_lshr_b32 s35, s35, 16
    s_mul_i32 s36, s35, 24
    s_sub_u32 s36, s42, s36
    s_mov_b32 s45, 3072
    s_lshr_b32 s38, s36, 3
    s_and_b32 s39, s36, 7
    s_mul_i32 s40, s39, 196608
    s_mul_i32 s41, s35, 12288
    s_add_u32 s40, s40, s41
    s_lshl_b32 s41, s38, 10
    s_add_u32 s40, s40, s41
    s_add_u32 s40, s40, 27262976
    s_mov_b32 s46, 98304
    s_mov_b32 s47, 3072
    s_lshl_b32 s48, s35, 2
    s_mul_i32 s41, s39, 6144
    s_add_u32 s48, s48, s41
    s_lshl_b32 s41, s38, 10
    s_add_u32 s48, s48, s41
    s_add_u32 s48, s48, 6619136
attn1_kernel_w_go:
    v_mul_lo_u32 v104, v104, s45
    v_add_u32 v104, v104, v105
    s_lshl_b32 s49, s45, 6
    s_mul_i32 s37, s35, s49
    s_lshl_b32 s38, s36, 7
    s_add_u32 s37, s37, s38
    s_lshl_b32 s49, s45, 3
    s_add_u32 m0, s34, 0
    s_nop 0
    buffer_load_dwordx4 v104, s[16:19], s37 offen lds
    s_add_u32 s37, s37, s49
    s_add_u32 m0, s34, 1024
    s_nop 0
    buffer_load_dwordx4 v104, s[16:19], s37 offen lds
    s_add_u32 s37, s37, s49
    s_add_u32 m0, s34, 2048
    s_nop 0
    buffer_load_dwordx4 v104, s[16:19], s37 offen lds
    s_add_u32 s37, s37, s49
    s_add_u32 m0, s34, 3072
    s_nop 0
    buffer_load_dwordx4 v104, s[16:19], s37 offen lds
    s_add_u32 s37, s37, s49
    s_add_u32 m0, s34, 4096
    s_nop 0
    buffer_load_dwordx4 v104, s[16:19], s37 offen lds
    s_add_u32 s37, s37, s49
    s_add_u32 m0, s34, 5120
    s_nop 0
    buffer_load_dwordx4 v104, s[16:19], s37 offen lds
    s_add_u32 s37, s37, s49
    s_add_u32 m0, s34, 6144
    s_nop 0
    buffer_load_dwordx4 v104, s[16:19], s37 offen lds
    s_add_u32 s37, s37, s49
    s_add_u32 m0, s34, 7168
    s_nop 0
    buffer_load_dwordx4 v104, s[16:19], s37 offen lds
    s_add_u32 s37, s37, s49
    v_lshlrev_b32 v108, 5, v108
    v_add_u32 v108, v108, v110
    v_add_u32 v109, v107, v108
    v_xor_b32 v108, 64, v108
    v_add_u32 v110, v107, v108
    v_mov_b32 v32, 0
    v_mov_b32 v33, 0
    s_mov_b32 s50, s40
    s_add_u32 s51, s50, s47
    s_add_u32 s52, s51, s47
    s_add_u32 s53, s52, s47
    s_cmp_lt_u32 s67, 704
    s_cbranch_scc1 attn1_kernel_w_nowd
    s_mul_i32 s54, s36, 229376
    s_add_u32 s54, s54, 33554432
    s_lshl_b32 s55, s35, 2
    s_add_u32 s55, s55, 0
    s_mul_i32 s56, s55, 9363
    s_lshr_b32 s56, s56, 16
    s_mul_i32 s57, s56, 7
    s_sub_u32 s55, s55, s57
    s_lshl_b32 s57, s56, 2
    s_add_u32 s57, s57, s55
    s_mul_i32 s56, s56, 3
    s_add_u32 s56, s56, s55
    s_add_u32 s56, s56, 60
    s_cmp_lt_u32 s55, 4
    s_cselect_b32 s57, s57, s56
    s_lshl_b32 s57, s57, 11
    s_add_u32 s50, s54, s57
    s_lshl_b32 s55, s35, 2
    s_add_u32 s55, s55, 1
    s_mul_i32 s56, s55, 9363
    s_lshr_b32 s56, s56, 16
    s_mul_i32 s57, s56, 7
    s_sub_u32 s55, s55, s57
    s_lshl_b32 s57, s56, 2
    s_add_u32 s57, s57, s55
    s_mul_i32 s56, s56, 3
    s_add_u32 s56, s56, s55
    s_add_u32 s56, s56, 60
    s_cmp_lt_u32 s55, 4
    s_cselect_b32 s57, s57, s56
    s_lshl_b32 s57, s57, 11
    s_add_u32 s51, s54, s57
    s_lshl_b32 s55, s35, 2
    s_add_u32 s55, s55, 2
    s_mul_i32 s56, s55, 9363
    s_lshr_b32 s56, s56, 16
    s_mul_i32 s57, s56, 7
    s_sub_u32 s55, s55, s57
    s_lshl_b32 s57, s56, 2
    s_add_u32 s57, s57, s55
    s_mul_i32 s56, s56, 3
    s_add_u32 s56, s56, s55
    s_add_u32 s56, s56, 60
    s_cmp_lt_u32 s55, 4
    s_cselect_b32 s57, s57, s56
    s_lshl_b32 s57, s57, 11
    s_add_u32 s52, s54, s57
    s_lshl_b32 s55, s35, 2
    s_add_u32 s55, s55, 3
    s_mul_i32 s56, s55, 9363
    s_lshr_b32 s56, s56, 16
    s_mul_i32 s57, s56, 7
    s_sub_u32 s55, s55, s57
    s_lshl_b32 s57, s56, 2
    s_add_u32 s57, s57, s55
    s_mul_i32 s56, s56, 3
    s_add_u32 s56, s56, s55
    s_add_u32 s56, s56, 60
    s_cmp_lt_u32 s55, 4
    s_cselect_b32 s57, s57, s56
    s_lshl_b32 s57, s57, 11
    s_add_u32 s53, s54, s57
attn1_kernel_w_nowd:
    s_waitcnt vmcnt(0)
    ds_read_b64_tr_b16 v[0:1], v109 offset:0
    ds_read_b64_tr_b16 v[2:3], v109 offset:1024
    ds_read_b64_tr_b16 v[4:5], v110 offset:0
    ds_read_b64_tr_b16 v[6:7], v110 offset:1024
    ds_read_b64_tr_b16 v[8:9], v109 offset:2048
    ds_read_b64_tr_b16 v[10:11], v109 offset:3072
    ds_read_b64_tr_b16 v[12:13], v110 offset:2048
    ds_read_b64_tr_b16 v[14:15], v110 offset:3072
    ds_read_b64_tr_b16 v[16:17], v109 offset:4096
    ds_read_b64_tr_b16 v[18:19], v109 offset:5120
    ds_read_b64_tr_b16 v[20:21], v110 offset:4096
    ds_read_b64_tr_b16 v[22:23], v110 offset:5120
    ds_read_b64_tr_b16 v[24:25], v109 offset:6144
    ds_read_b64_tr_b16 v[26:27], v109 offset:7168
    ds_read_b64_tr_b16 v[28:29], v110 offset:6144
    ds_read_b64_tr_b16 v[30:31], v110 offset:7168
    s_waitcnt lgkmcnt(0)
    buffer_store_dwordx4 v[0:3], v103, s[12:15], s50 offen sc1
    v_dot2c_f32_bf16 v32, s33, v0
    v_dot2c_f32_bf16 v32, s33, v1
    v_dot2c_f32_bf16 v32, s33, v2
    v_dot2c_f32_bf16 v32, s33, v3
    s_add_u32 s50, s50, s46
    buffer_store_dwordx4 v[4:7], v103, s[12:15], s50 offen sc1
    v_dot2c_f32_bf16 v33, s33, v4
    v_dot2c_f32_bf16 v33, s33, v5
    v_dot2c_f32_bf16 v33, s33, v6
    v_dot2c_f32_bf16 v33, s33, v7
    s_add_u32 s50, s50, s46
    buffer_store_dwordx4 v[8:11], v103, s[12:15], s51 offen sc1
    v_dot2c_f32_bf16 v32, s33, v8
    v_dot2c_f32_bf16 v32, s33, v9
    v_dot2c_f32_bf16 v32, s33, v10
    v_dot2c_f32_bf16 v32, s33, v11
    s_add_u32 s51, s51, s46
    buffer_store_dwordx4 v[12:15], v103, s[12:15], s51 offen sc1
    v_dot2c_f32_bf16 v33, s33, v12
    v_dot2c_f32_bf16 v33, s33, v13
    v_dot2c_f32_bf16 v33, s33, v14
    v_dot2c_f32_bf16 v33, s33, v15
    s_add_u32 s51, s51, s46
    buffer_store_dwordx4 v[16:19], v103, s[12:15], s52 offen sc1
    v_dot2c_f32_bf16 v32, s33, v16
    v_dot2c_f32_bf16 v32, s33, v17
    v_dot2c_f32_bf16 v32, s33, v18
    v_dot2c_f32_bf16 v32, s33, v19
    s_add_u32 s52, s52, s46
    buffer_store_dwordx4 v[20:23], v103, s[12:15], s52 offen sc1
    v_dot2c_f32_bf16 v33, s33, v20
    v_dot2c_f32_bf16 v33, s33, v21
    v_dot2c_f32_bf16 v33, s33, v22
    v_dot2c_f32_bf16 v33, s33, v23
    s_add_u32 s52, s52, s46
    buffer_store_dwordx4 v[24:27], v103, s[12:15], s53 offen sc1
    v_dot2c_f32_bf16 v32, s33, v24
    v_dot2c_f32_bf16 v32, s33, v25
    v_dot2c_f32_bf16 v32, s33, v26
    v_dot2c_f32_bf16 v32, s33, v27
    s_add_u32 s53, s53, s46
    buffer_store_dwordx4 v[28:31], v103, s[12:15], s53 offen sc1
    v_dot2c_f32_bf16 v33, s33, v28
    v_dot2c_f32_bf16 v33, s33, v29
    v_dot2c_f32_bf16 v33, s33, v30
    v_dot2c_f32_bf16 v33, s33, v31
    s_add_u32 s53, s53, s46
    s_cmp_ge_u32 s67, 640
    s_cbranch_scc1 attn1_kernel_wnext
    s_nop 1
    v_mov_b32 v34, v32
    v_mov_b32 v35, v33
    s_nop 1
    v_permlane32_swap_b32 v32, v34
    v_permlane32_swap_b32 v33, v35
    s_nop 1
    v_add_f32 v32, v32, v34
    v_add_f32 v33, v33, v35
    v_lshlrev_b32 v104, 5, v102
    s_mov_b64 exec, 0xffffffff
    buffer_store_dword v32, v104, s[12:15], s48 offen
    buffer_store_dword v33, v104, s[12:15], s48 offen offset:3072
    s_branch attn1_kernel_wnext
attn1_kernel_w_gu:
    s_mov_b32 s16, s28
    s_and_b32 s17, s29, 0xffff
    s_mov_b32 s18, 1835008
    s_mov_b32 s19, 0x00020000
    s_mov_b32 s20, s30
    s_and_b32 s21, s31, 0xffff
    s_mov_b32 s22, 1835008
    s_mov_b32 s23, 0x00020000
    s_mov_b32 s42, s67
    s_mul_i32 s35, s42, 2341
    s_lshr_b32 s35, s35, 16
    s_mul_i32 s36, s35, 28
    s_sub_u32 s36, s42, s36
    v_mul_u32_u24 v104, 3584, v104
    v_add_u32 v104, v104, v105
    s_mul_i32 s37, s35, 114688
    s_lshl_b32 s38, s36, 7
    s_add_u32 s37, s37, s38
    s_add_u32 m0, s34, 0
    s_nop 0
    buffer_load_dwordx4 v104, s[16:19], s37 offen lds
    s_add_u32 m0, s34, 4096
    s_nop 0
    buffer_load_dwordx4 v104, s[20:23], s37 offen lds
    s_add_u32 s37, s37, 28672
    s_add_u32 m0, s34, 1024
    s_nop 0
    buffer_load_dwordx4 v104, s[16:19], s37 offen lds
    s_add_u32 m0, s34, 5120
    s_nop 0
    buffer_load_dwordx4 v104, s[20:23], s37 offen lds
    s_add_u32 s37, s37, 28672
    s_add_u32 m0, s34, 2048
    s_nop 0
    buffer_load_dwordx4 v104, s[16:19], s37 offen lds
    s_add_u32 m0, s34, 6144
    s_nop 0
    buffer_load_dwordx4 v104, s[20:23], s37 offen lds
    s_add_u32 s37, s37, 28672
    s_add_u32 m0, s34, 3072
    s_nop 0
    buffer_load_dwordx4 v104, s[16:19], s37 offen lds
    s_add_u32 m0, s34, 7168
    s_nop 0
    buffer_load_dwordx4 v104, s[20:23], s37 offen lds
    s_add_u32 s37, s37, 28672
    v_lshlrev_b32 v108, 12, v108
    v_add3_u32 v109, v107, v108, v110
    v_xor_b32 v110, 64, v110
    v_add3_u32 v110, v107, v108, v110
    v_mov_b32 v32, 0
    v_mov_b32 v33, 0
    v_mov_b32 v34, 0
    v_mov_b32 v35, 0
    s_lshl_b32 s43, s36, 2
    s_add_u32 s43, s43, 0
    s_mul_i32 s44, s43, 9363
    s_lshr_b32 s44, s44, 16
    s_mul_i32 s45, s44, 7
    s_sub_u32 s45, s43, s45
    s_mul_i32 s46, s44, 229376
    s_lshl_b32 s54, s45, 10
    s_add_u32 s46, s46, s54
    s_mul_i32 s54, s35, 14336
    s_add_u32 s46, s46, s54
    s_add_u32 s46, s46, 29360128
    s_add_u32 s56, s46, 7168
    s_lshl_b32 s43, s36, 2
    s_add_u32 s43, s43, 1
    s_mul_i32 s44, s43, 9363
    s_lshr_b32 s44, s44, 16
    s_mul_i32 s45, s44, 7
    s_sub_u32 s45, s43, s45
    s_mul_i32 s47, s44, 229376
    s_lshl_b32 s54, s45, 10
    s_add_u32 s47, s47, s54
    s_mul_i32 s54, s35, 14336
    s_add_u32 s47, s47, s54
    s_add_u32 s47, s47, 29360128
    s_add_u32 s57, s47, 7168
    s_lshl_b32 s43, s36, 2
    s_add_u32 s43, s43, 2
    s_mul_i32 s44, s43, 9363
    s_lshr_b32 s44, s44, 16
    s_mul_i32 s45, s44, 7
    s_sub_u32 s45, s43, s45
    s_mul_i32 s48, s44, 229376
    s_lshl_b32 s54, s45, 10
    s_add_u32 s48, s48, s54
    s_mul_i32 s54, s35, 14336
    s_add_u32 s48, s48, s54
    s_add_u32 s48, s48, 29360128
    s_add_u32 s58, s48, 7168
    s_lshl_b32 s43, s36, 2
    s_add_u32 s43, s43, 3
    s_mul_i32 s44, s43, 9363
    s_lshr_b32 s44, s44, 16
    s_mul_i32 s45, s44, 7
    s_sub_u32 s45, s43, s45
    s_mul_i32 s49, s44, 229376
    s_lshl_b32 s54, s45, 10
    s_add_u32 s49, s49, s54
    s_mul_i32 s54, s35, 14336
    s_add_u32 s49, s49, s54
    s_add_u32 s49, s49, 29360128
    s_add_u32 s59, s49, 7168
    s_lshl_b32 s50, s35, 2
    s_lshl_b32 s51, s36, 13
    s_add_u32 s50, s50, s51
    s_add_u32 s50, s50, 6684672
    s_add_u32 s51, s50, 4096
    s_waitcnt vmcnt(0)
    ds_read_b64_tr_b16 v[0:1], v109 offset:0
    ds_read_b64_tr_b16 v[2:3], v109 offset:1024
    ds_read_b64_tr_b16 v[4:5], v109 offset:32
    ds_read_b64_tr_b16 v[6:7], v109 offset:1056
    ds_read_b64_tr_b16 v[8:9], v110 offset:0
    ds_read_b64_tr_b16 v[10:11], v110 offset:1024
    ds_read_b64_tr_b16 v[12:13], v110 offset:32
    ds_read_b64_tr_b16 v[14:15], v110 offset:1056
    ds_read_b64_tr_b16 v[16:17], v109 offset:2048
    ds_read_b64_tr_b16 v[18:19], v109 offset:3072
    ds_read_b64_tr_b16 v[20:21], v109 offset:2080
    ds_read_b64_tr_b16 v[22:23], v109 offset:3104
    ds_read_b64_tr_b16 v[24:25], v110 offset:2048
    ds_read_b64_tr_b16 v[26:27], v110 offset:3072
    ds_read_b64_tr_b16 v[28:29], v110 offset:2080
    ds_read_b64_tr_b16 v[30:31], v110 offset:3104
    s_waitcnt lgkmcnt(0)
    buffer_store_dwordx4 v[0:3], v103, s[12:15], s46 offen sc1
    v_dot2c_f32_bf16 v32, s33, v0
    v_dot2c_f32_bf16 v32, s33, v1
    v_dot2c_f32_bf16 v32, s33, v2
    v_dot2c_f32_bf16 v32, s33, v3
    buffer_store_dwordx4 v[4:7], v103, s[12:15], s47 offen sc1
    v_dot2c_f32_bf16 v33, s33, v4
    v_dot2c_f32_bf16 v33, s33, v5
    v_dot2c_f32_bf16 v33, s33, v6
    v_dot2c_f32_bf16 v33, s33, v7
    buffer_store_dwordx4 v[8:11], v103, s[12:15], s48 offen sc1
    v_dot2c_f32_bf16 v34, s33, v8
    v_dot2c_f32_bf16 v34, s33, v9
    v_dot2c_f32_bf16 v34, s33, v10
    v_dot2c_f32_bf16 v34, s33, v11
    buffer_store_dwordx4 v[12:15], v103, s[12:15], s49 offen sc1
    v_dot2c_f32_bf16 v35, s33, v12
    v_dot2c_f32_bf16 v35, s33, v13
    v_dot2c_f32_bf16 v35, s33, v14
    v_dot2c_f32_bf16 v35, s33, v15
    buffer_store_dwordx4 v[16:19], v103, s[12:15], s56 offen sc1
    v_dot2c_f32_bf16 v32, s33, v16
    v_dot2c_f32_bf16 v32, s33, v17
    v_dot2c_f32_bf16 v32, s33, v18
    v_dot2c_f32_bf16 v32, s33, v19
    buffer_store_dwordx4 v[20:23], v103, s[12:15], s57 offen sc1
    v_dot2c_f32_bf16 v33, s33, v20
    v_dot2c_f32_bf16 v33, s33, v21
    v_dot2c_f32_bf16 v33, s33, v22
    v_dot2c_f32_bf16 v33, s33, v23
    buffer_store_dwordx4 v[24:27], v103, s[12:15], s58 offen sc1
    v_dot2c_f32_bf16 v34, s33, v24
    v_dot2c_f32_bf16 v34, s33, v25
    v_dot2c_f32_bf16 v34, s33, v26
    v_dot2c_f32_bf16 v34, s33, v27
    buffer_store_dwordx4 v[28:31], v103, s[12:15], s59 offen sc1
    v_dot2c_f32_bf16 v35, s33, v28
    v_dot2c_f32_bf16 v35, s33, v29
    v_dot2c_f32_bf16 v35, s33, v30
    v_dot2c_f32_bf16 v35, s33, v31
    s_nop 2
    v_mov_b32 v36, v32
    v_mov_b32 v37, v33
    v_mov_b32 v38, v34
    v_mov_b32 v39, v35
    s_nop 1
    v_permlane32_swap_b32 v32, v36
    v_permlane32_swap_b32 v33, v37
    v_permlane32_swap_b32 v34, v38
    v_permlane32_swap_b32 v35, v39
    s_nop 1
    v_add_f32 v32, v32, v36
    v_add_f32 v33, v33, v37
    v_add_f32 v34, v34, v38
    v_add_f32 v35, v35, v39
    v_lshlrev_b32 v104, 6, v102
    s_mov_b64 exec, 0xffffffff
    buffer_store_dword v32, v104, s[12:15], s50 offen offset:0
    buffer_store_dword v33, v104, s[12:15], s50 offen offset:2048
    buffer_store_dword v34, v104, s[12:15], s51 offen offset:0
    buffer_store_dword v35, v104, s[12:15], s51 offen offset:2048
    s_branch attn1_kernel_wnext
attn1_kernel_wnext:
    s_mov_b64 exec, -1
    s_add_u32 s67, s67, 768
    s_cmp_lt_u32 s67, 928
    s_cbranch_scc1 attn1_kernel_wloop
attn1_kernel_hdone:
    s_mov_b64 exec, -1
    s_cmp_ge_u32 s2, 4
    s_cbranch_scc1 attn1_kernel_nozero
    s_cmp_lg_u32 s26, 15
    s_cbranch_scc1 attn1_kernel_nozero
    v_mov_b32 v0, 0
    v_mov_b32 v1, 0
    v_mov_b32 v2, 0
    v_mov_b32 v3, 0
    s_lshl_b32 s45, s2, 12
    s_add_u32 s45, s45, 36700160
    buffer_store_dwordx4 v[0:3], v103, s[12:15], s45 offen sc1
    buffer_store_dwordx4 v[0:3], v103, s[12:15], s45 offen offset:1024 sc1
    buffer_store_dwordx4 v[0:3], v103, s[12:15], s45 offen offset:2048 sc1
    buffer_store_dwordx4 v[0:3], v103, s[12:15], s45 offen offset:3072 sc1
attn1_kernel_nozero:
    s_mov_b64 exec, 1
    ds_add_u32 v118, v119 offset:68
    s_mov_b64 exec, -1
    s_branch attn1_kernel_pro
.globl blk1_kernel
.p2align 8
.type blk1_kernel,@function
blk1_kernel:
    s_mov_b32 s71, 0
    s_branch blk1_kernel_body
.globl blk2_kernel
.p2align 8
.type blk2_kernel,@function
blk2_kernel:
    s_mov_b32 s71, 1
blk1_kernel_body:
    s_cmp_ge_u32 s2, 256
    s_cbranch_scc1 blk1_kernel_end_real
    s_load_dwordx2 s[8:9], s[0:1], 72
    s_load_dwordx2 s[4:5], s[0:1], 56
    s_load_dwordx2 s[6:7], s[0:1], 0
    v_and_b32 v252, 63, v0
    v_lshrrev_b32 v254, 6, v0
    v_lshlrev_b32 v253, 4, v252
    v_readfirstlane_b32 s70, v254
    s_mov_b32 s14, 41943040
    s_mov_b32 s15, 0x00020000
    s_and_b32 s50, s2, 7
    s_lshr_b32 s51, s2, 3
    s_lshl_b32 s50, s50, 2
    s_and_b32 s69, s51, 3
    s_add_u32 s50, s50, s69
    s_lshr_b32 s51, s51, 2
    s_and_b32 s52, s70, 1
    s_lshr_b32 s53, s70, 1
    s_lshl_b32 s54, s50, 1
    s_add_u32 s54, s54, s52
    s_mul_i32 s55, s54, 32768
    s_lshl_b32 s69, s53, 11
    s_add_u32 s55, s55, s69
    s_add_u32 s55, s55, 8388608
    s_lshl_b32 s65, s52, 12
    s_add_u32 s65, s65, s69
    s_mul_i32 s64, s51, 65536
    s_lshl_b32 s68, s70, 11
    s_add_u32 s64, s64, s68
    s_add_u32 s64, s64, 24641536
    s_waitcnt lgkmcnt(0)
    s_mov_b32 s12, s8
    s_and_b32 s13, s9, 0xffff
    s_add_u32 m0, s65, 0
    s_nop 0
    buffer_load_dwordx4 v253, s[12:15], s55 offen lds
    buffer_load_dwordx4 v253, s[12:15], s55 offen offset:1024 lds
    s_add_u32 s55, s55, 4096
    s_add_u32 m0, s68, 8192
    s_nop 0
    buffer_load_dwordx4 v253, s[12:15], s64 offen lds
    buffer_load_dwordx4 v253, s[12:15], s64 offen offset:1024 lds
    s_add_u32 s64, s64, 8192
    s_add_u32 m0, s65, 16384
    s_nop 0
    buffer_load_dwordx4 v253, s[12:15], s55 offen lds
    buffer_load_dwordx4 v253, s[12:15], s55 offen offset:1024 lds
    s_add_u32 s55, s55, 4096
    s_add_u32 m0, s68, 24576
    s_nop 0
    buffer_load_dwordx4 v253, s[12:15], s64 offen lds
    buffer_load_dwordx4 v253, s[12:15], s64 offen offset:1024 lds
    s_add_u32 s64, s64, 8192
    s_add_u32 m0, s65, 32768
    s_nop 0
    buffer_load_dwordx4 v253, s[12:15], s55 offen lds
    buffer_load_dwordx4 v253, s[12:15], s55 offen offset:1024 lds
    s_add_u32 s55, s55, 4096
    s_add_u32 m0, s68, 40960
    s_nop 0
    buffer_load_dwordx4 v253, s[12:15], s64 offen lds
    buffer_load_dwordx4 v253, s[12:15], s64 offen offset:1024 lds
    s_add_u32 s64, s64, 8192
    s_lshl_b32 s56, s54, 15
    s_lshl_b32 s57, s51, 12
    s_lshl_b32 s58, s53, 11
    s_add_u32 s57, s57, s58
    s_add_u32 s57, s57, s56
    s_cmp_eq_u32 s71, 0
    s_cbranch_scc1 blk1_kernel_rnat
    s_add_u32 s58, s57, 12582912
    buffer_load_dwordx4 v[48:51], v253, s[12:15], s58 offen
    buffer_load_dwordx4 v[52:55], v253, s[12:15], s58 offen offset:1024
    s_branch blk1_kernel_rdone
blk1_kernel_rnat:
    s_mov_b32 s60, s6
    s_and_b32 s61, s7, 0xffff
    s_mov_b32 s62, 2097152
    s_mov_b32 s63, 0x00020000
    s_lshl_b32 s58, s51, 7
    s_lshl_b32 s59, s53, 6
    s_add_u32 s58, s58, s59
    s_add_u32 s58, s58, s56
    v_and_b32 v64, 31, v252
    v_lshlrev_b32 v64, 10, v64
    v_lshrrev_b32 v65, 5, v252
    v_lshl_add_u32 v64, v65, 4, v64
    buffer_load_dwordx4 v[48:51], v64, s[60:63], s58 offen
    buffer_load_dwordx4 v[52:55], v64, s[60:63], s58 offen offset:32
blk1_kernel_rdone:
    s_lshl_b32 s59, s52, 12
    v_add_u32 v56, s59, v253
    v_add_u32 v57, 57344, v56
    v_add_u32 v58, 114688, v56
    s_lshl_b32 s59, s53, 10
    v_add_u32 v59, s59, v253
    v_add_u32 v60, 57344, v59
    v_add_u32 v61, 114688, v59
    s_waitcnt vmcnt(10)
    s_barrier
    ds_read_b128 v[96:99], v56 offset:0
    ds_read_b128 v[112:115], v59 offset:8192
    s_add_u32 m0, s65, 49152
    s_nop 0
    buffer_load_dwordx4 v253, s[12:15], s55 offen lds
    ds_read_b128 v[100:103], v56 offset:1024
    ds_read_b128 v[116:119], v59 offset:10240
    buffer_load_dwordx4 v253, s[12:15], s55 offen offset:1024 lds
    s_add_u32 s55, s55, 4096
    ds_read_b128 v[104:107], v56 offset:2048
    ds_read_b128 v[120:123], v59 offset:12288
    s_add_u32 m0, s68, 65536
    s_nop 0
    buffer_load_dwordx4 v253, s[12:15], s64 offen lds
    ds_read_b128 v[108:111], v56 offset:3072
    ds_read_b128 v[124:127], v59 offset:14336
    buffer_load_dwordx4 v253, s[12:15], s64 offen offset:1024 lds
    s_add_u32 s64, s64, 8192
    s_waitcnt vmcnt(10)
    s_barrier
    s_waitcnt lgkmcnt(6)
    v_mfma_f32_32x32x16_bf16 v[0:15], v[112:115], v[96:99], 0
    ds_read_b128 v[128:131], v56 offset:16384
    ds_read_b128 v[144:147], v59 offset:24576
    s_add_u32 m0, s65, 81920
    s_nop 0
    buffer_load_dwordx4 v253, s[12:15], s55 offen lds
    s_waitcnt lgkmcnt(6)
    v_mfma_f32_32x32x16_bf16 v[0:15], v[116:119], v[100:103], v[0:15]
    ds_read_b128 v[132:135], v56 offset:17408
    ds_read_b128 v[148:151], v59 offset:26624
    buffer_load_dwordx4 v253, s[12:15], s55 offen offset:1024 lds
    s_add_u32 s55, s55, 4096
    s_waitcnt lgkmcnt(6)
    v_mfma_f32_32x32x16_bf16 v[0:15], v[120:123], v[104:107], v[0:15]
    ds_read_b128 v[136:139], v56 offset:18432
    ds_read_b128 v[152:155], v59 offset:28672
    s_add_u32 m0, s68, 98304
    s_nop 0
    buffer_load_dwordx4 v253, s[12:15], s64 offen lds
    s_waitcnt lgkmcnt(6)
    v_mfma_f32_32x32x16_bf16 v[0:15], v[124:127], v[108:111], v[0:15]
    ds_read_b128 v[140:143], v56 offset:19456
    ds_read_b128 v[156:159], v59 offset:30720
    buffer_load_dwordx4 v253, s[12:15], s64 offen offset:1024 lds
    s_add_u32 s64, s64, 8192
    s_waitcnt vmcnt(10)
    s_barrier
    s_waitcnt lgkmcnt(6)
    v_mfma_f32_32x32x16_bf16 v[0:15], v[144:147], v[128:131], v[0:15]
    ds_read_b128 v[96:99], v56 offset:32768
    ds_read_b128 v[112:115], v59 offset:40960
    s_add_u32 m0, s65, 114688
    s_nop 0
    buffer_load_dwordx4 v253, s[12:15], s55 offen lds
    s_waitcnt lgkmcnt(6)
    v_mfma_f32_32x32x16_bf16 v[0:15], v[148:151], v[132:135], v[0:15]
    ds_read_b128 v[100:103], v56 offset:33792
    ds_read_b128 v[116:119], v59 offset:43008
    buffer_load_dwordx4 v253, s[12:15], s55 offen offset:1024 lds
    s_add_u32 s55, s55, 4096
    s_waitcnt lgkmcnt(6)
    v_mfma_f32_32x32x16_bf16 v[0:15], v[152:155], v[136:139], v[0:15]
    ds_read_b128 v[104:107], v56 offset:34816
    ds_read_b128 v[120:123], v59 offset:45056
    s_add_u32 m0, s68, 57344
    s_nop 0
    buffer_load_dwordx4 v253, s[12:15], s64 offen lds
    s_waitcnt lgkmcnt(6)
    v_mfma_f32_32x32x16_bf16 v[0:15], v[156:159], v[140:143], v[0:15]
    ds_read_b128 v[108:111], v56 offset:35840
    ds_read_b128 v[124:127], v59 offset:47104
    buffer_load_dwordx4 v253, s[12:15], s64 offen offset:1024 lds
    s_add_u32 s64, s64, 8192
    s_waitcnt vmcnt(8)
    s_barrier
    s_waitcnt lgkmcnt(6)
    v_mfma_f32_32x32x16_bf16 v[0:15], v[112:115], v[96:99], v[0:15]
    ds_read_b128 v[128:131], v56 offset:49152
    ds_read_b128 v[144:147], v60 offset:8192
    s_add_u32 m0, s65, 73728
    s_nop 0
    buffer_load_dwordx4 v253, s[12:15], s55 offen lds
    s_waitcnt lgkmcnt(6)
    v_mfma_f32_32x32x16_bf16 v[0:15], v[116:119], v[100:103], v[0:15]
    ds_read_b128 v[132:135], v56 offset:50176
    ds_read_b128 v[148:151], v60 offset:10240
    buffer_load_dwordx4 v253, s[12:15], s55 offen offset:1024 lds
    s_add_u32 s55, s55, 4096
    s_waitcnt lgkmcnt(6)
    v_mfma_f32_32x32x16_bf16 v[0:15], v[120:123], v[104:107], v[0:15]
    ds_read_b128 v[136:139], v56 offset:51200
    ds_read_b128 v[152:155], v60 offset:12288
    s_add_u32 m0, s68, 90112
    s_nop 0
    buffer_load_dwordx4 v253, s[12:15], s64 offen lds
    s_waitcnt lgkmcnt(6)
    v_mfma_f32_32x32x16_bf16 v[0:15], v[124:127], v[108:111], v[0:15]
    ds_read_b128 v[140:143], v56 offset:52224
    ds_read_b128 v[156:159], v60 offset:14336
    buffer_load_dwordx4 v253, s[12:15], s64 offen offset:1024 lds
    s_add_u32 s64, s64, 8192
    s_waitcnt vmcnt(8)
    s_barrier
    s_waitcnt lgkmcnt(6)
    v_mfma_f32_32x32x16_bf16 v[0:15], v[144:147], v[128:131], v[0:15]
    ds_read_b128 v[96:99], v57 offset:24576
    ds_read_b128 v[112:115], v60 offset:40960
    s_add_u32 m0, s65, 106496
    s_nop 0
    buffer_load_dwordx4 v253, s[12:15], s55 offen lds
    s_waitcnt lgkmcnt(6)
    v_mfma_f32_32x32x16_bf16 v[0:15], v[148:151], v[132:135], v[0:15]
    ds_read_b128 v[100:103], v57 offset:25600
    ds_read_b128 v[116:119], v60 offset:43008
    buffer_load_dwordx4 v253, s[12:15], s55 offen offset:1024 lds
    s_add_u32 s55, s55, 4096
    s_waitcnt lgkmcnt(6)
    v_mfma_f32_32x32x16_bf16 v[0:15], v[152:155], v[136:139], v[0:15]
    ds_read_b128 v[104:107], v57 offset:26624
    ds_read_b128 v[120:123], v60 offset:45056
    s_add_u32 m0, s68, 122880
    s_nop 0
    buffer_load_dwordx4 v253, s[12:15], s64 offen lds
    s_waitcnt lgkmcnt(6)
    v_mfma_f32_32x32x16_bf16 v[0:15], v[156:159], v[140:143], v[0:15]
    ds_read_b128 v[108:111], v57 offset:27648
    ds_read_b128 v[124:127], v60 offset:47104
    buffer_load_dwordx4 v253, s[12:15], s64 offen offset:1024 lds
    s_add_u32 s64, s64, 8192
    s_and_b32 s44, s2, 7
    s_lshr_b32 s45, s2, 3
    s_and_b32 s43, s44, 1
    s_lshl_b32 s43, s43, 3
    s_lshr_b32 s40, s44, 1
    s_lshl_b32 s40, s40, 2
    s_and_b32 s44, s45, 7
    s_add_u32 s43, s43, s44
    s_lshr_b32 s45, s45, 3
    s_add_u32 s40, s40, s45
    s_and_b32 s44, s2, 7
    s_lshr_b32 s45, s2, 3
    s_and_b32 s43, s44, 3
    s_lshl_b32 s43, s43, 2
    s_lshr_b32 s41, s44, 2
    s_lshl_b32 s41, s41, 3
    s_and_b32 s44, s45, 3
    s_add_u32 s43, s43, s44
    s_lshr_b32 s45, s45, 2
    s_add_u32 s41, s41, s45
    s_mul_i32 s40, s40, 14336
    s_add_u32 s40, s40, 6684672
    s_mul_i32 s41, s41, 3072
    s_add_u32 s41, s41, 6619136
    s_lshl_b32 s42, s70, 6
    v_add_u32 v220, s42, v252
    v_lshlrev_b32 v221, 6, v220
    buffer_load_dwordx4 v[196:199], v221, s[12:15], s40 offen offset:0
    buffer_load_dwordx4 v[200:203], v221, s[12:15], s40 offen offset:16
    buffer_load_dwordx4 v[204:207], v221, s[12:15], s40 offen offset:32
    buffer_load_dwordx4 v[208:211], v221, s[12:15], s40 offen offset:48
    v_lshlrev_b32 v221, 5, v220
    buffer_load_dwordx4 v[212:215], v221, s[12:15], s41 offen offset:0
    buffer_load_dwordx4 v[216:219], v221, s[12:15], s41 offen offset:16
    s_waitcnt vmcnt(14)
    s_barrier
    s_waitcnt lgkmcnt(6)
    v_mfma_f32_32x32x16_bf16 v[0:15], v[112:115], v[96:99], v[0:15]
    ds_read_b128 v[128:131], v58 offset:0
    ds_read_b128 v[144:147], v60 offset:0
    s_waitcnt lgkmcnt(6)
    v_mfma_f32_32x32x16_bf16 v[0:15], v[116:119], v[100:103], v[0:15]
    ds_read_b128 v[132:135], v58 offset:1024
    ds_read_b128 v[148:151], v60 offset:2048
    s_waitcnt lgkmcnt(6)
    v_mfma_f32_32x32x16_bf16 v[0:15], v[120:123], v[104:107], v[0:15]
    ds_read_b128 v[136:139], v58 offset:2048
    ds_read_b128 v[152:155], v60 offset:4096
    s_waitcnt lgkmcnt(6)
    v_mfma_f32_32x32x16_bf16 v[0:15], v[124:127], v[108:111], v[0:15]
    ds_read_b128 v[140:143], v58 offset:3072
    ds_read_b128 v[156:159], v60 offset:6144
    s_waitcnt vmcnt(10)
    s_barrier
    s_waitcnt lgkmcnt(6)
    v_mfma_f32_32x32x16_bf16 v[0:15], v[144:147], v[128:131], v[0:15]
    ds_read_b128 v[96:99], v57 offset:16384
    ds_read_b128 v[112:115], v60 offset:32768
    s_waitcnt lgkmcnt(6)
    v_mfma_f32_32x32x16_bf16 v[0:15], v[148:151], v[132:135], v[0:15]
    ds_read_b128 v[100:103], v57 offset:17408
    ds_read_b128 v[116:119], v60 offset:34816
    s_waitcnt lgkmcnt(6)
    v_mfma_f32_32x32x16_bf16 v[0:15], v[152:155], v[136:139], v[0:15]
    ds_read_b128 v[104:107], v57 offset:18432
    ds_read_b128 v[120:123], v60 offset:36864
    s_waitcnt lgkmcnt(6)
    v_mfma_f32_32x32x16_bf16 v[0:15], v[156:159], v[140:143], v[0:15]
    ds_read_b128 v[108:111], v57 offset:19456
    ds_read_b128 v[124:127], v60 offset:38912
    s_waitcnt vmcnt(6)
    s_barrier
    s_waitcnt lgkmcnt(6)
    v_mfma_f32_32x32x16_bf16 v[0:15], v[112:115], v[96:99], v[0:15]
    ds_read_b128 v[128:131], v57 offset:49152
    ds_read_b128 v[144:147], v61 offset:8192
    s_waitcnt lgkmcnt(6)
    v_mfma_f32_32x32x16_bf16 v[0:15], v[116:119], v[100:103], v[0:15]
    ds_read_b128 v[132:135], v57 offset:50176
    ds_read_b128 v[148:151], v61 offset:10240
    s_waitcnt lgkmcnt(6)
    v_mfma_f32_32x32x16_bf16 v[0:15], v[120:123], v[104:107], v[0:15]
    ds_read_b128 v[136:139], v57 offset:51200
    ds_read_b128 v[152:155], v61 offset:12288
    s_waitcnt lgkmcnt(6)
    v_mfma_f32_32x32x16_bf16 v[0:15], v[124:127], v[108:111], v[0:15]
    ds_read_b128 v[140:143], v57 offset:52224
    ds_read_b128 v[156:159], v61 offset:14336
    s_waitcnt lgkmcnt(6)
    v_mfma_f32_32x32x16_bf16 v[0:15], v[144:147], v[128:131], v[0:15]
    s_waitcnt lgkmcnt(4)
    v_mfma_f32_32x32x16_bf16 v[0:15], v[148:151], v[132:135], v[0:15]
    s_waitcnt lgkmcnt(2)
    v_mfma_f32_32x32x16_bf16 v[0:15], v[152:155], v[136:139], v[0:15]
    s_waitcnt lgkmcnt(0)
    v_mfma_f32_32x32x16_bf16 v[0:15], v[156:159], v[140:143], v[0:15]
    s_barrier
    s_cmp_lg_u32 s71, 0
    s_cbranch_scc1 blk1_kernel_noswap
    v_permlane32_swap_b32 v48, v50
    v_permlane32_swap_b32 v49, v51
    v_permlane32_swap_b32 v52, v54
    v_permlane32_swap_b32 v53, v55
    s_nop 1
blk1_kernel_noswap:
    s_mov_b32 s47, 0xffff0000
    v_lshlrev_b32 v80, 16, v48
    v_and_b32 v81, s47, v48
    v_lshlrev_b32 v82, 16, v49
    v_and_b32 v83, s47, v49
    v_lshlrev_b32 v84, 16, v50
    v_and_b32 v85, s47, v50
    v_lshlrev_b32 v86, 16, v51
    v_and_b32 v87, s47, v51
    v_lshlrev_b32 v88, 16, v52
    v_and_b32 v89, s47, v52
    v_lshlrev_b32 v90, 16, v53
    v_and_b32 v91, s47, v53
    v_lshlrev_b32 v92, 16, v54
    v_and_b32 v93, s47, v54
    v_lshlrev_b32 v94, 16, v55
    v_and_b32 v95, s47, v55
    v_add_f32 v0, v0, v80
    v_add_f32 v1, v1, v81
    v_add_f32 v2, v2, v82
    v_add_f32 v3, v3, v83
    v_add_f32 v4, v4, v84
    v_add_f32 v5, v5, v85
    v_add_f32 v6, v6, v86
    v_add_f32 v7, v7, v87
    v_add_f32 v8, v8, v88
    v_add_f32 v9, v9, v89
    v_add_f32 v10, v10, v90
    v_add_f32 v11, v11, v91
    v_add_f32 v12, v12, v92
    v_add_f32 v13, v13, v93
    v_add_f32 v14, v14, v94
    v_add_f32 v15, v15, v95
    v_cvt_pk_bf16_f32 v48, v0, v1
    v_cvt_pk_bf16_f32 v49, v2, v3
    v_cvt_pk_bf16_f32 v50, v4, v5
    v_cvt_pk_bf16_f32 v51, v6, v7
    v_cvt_pk_bf16_f32 v52, v8, v9
    v_cvt_pk_bf16_f32 v53, v10, v11
    v_cvt_pk_bf16_f32 v54, v12, v13
    v_cvt_pk_bf16_f32 v55, v14, v15
    s_add_u32 s58, s57, 10485760
    buffer_store_dwordx4 v[48:51], v253, s[12:15], s58 offen sc1
    buffer_store_dwordx4 v[52:55], v253, s[12:15], s58 offen offset:1024 sc1
    v_and_b32 v64, 31, v252
    v_lshlrev_b32 v64, 3, v64
    s_lshr_b32 s58, s57, 3
    s_add_u32 s58, s58, 6356992
    v_lshlrev_b32 v80, 16, v48
    v_and_b32 v81, s47, v48
    v_lshlrev_b32 v82, 16, v49
    v_and_b32 v83, s47, v49
    v_lshlrev_b32 v84, 16, v50
    v_and_b32 v85, s47, v50
    v_lshlrev_b32 v86, 16, v51
    v_and_b32 v87, s47, v51
    v_lshlrev_b32 v88, 16, v52
    v_and_b32 v89, s47, v52
    v_lshlrev_b32 v90, 16, v53
    v_and_b32 v91, s47, v53
    v_lshlrev_b32 v92, 16, v54
    v_and_b32 v93, s47, v54
    v_lshlrev_b32 v94, 16, v55
    v_and_b32 v95, s47, v55
    v_add_f32 v66, v80, v81
    v_mul_f32 v67, v80, v80
    v_fmac_f32 v67, v81, v81
    v_add_f32 v66, v66, v82
    v_fmac_f32 v67, v82, v82
    v_add_f32 v66, v66, v83
    v_fmac_f32 v67, v83, v83
    v_add_f32 v66, v66, v84
    v_fmac_f32 v67, v84, v84
    v_add_f32 v66, v66, v85
    v_fmac_f32 v67, v85, v85
    v_add_f32 v66, v66, v86
    v_fmac_f32 v67, v86, v86
    v_add_f32 v66, v66, v87
    v_fmac_f32 v67, v87, v87
    v_add_f32 v66, v66, v88
    v_fmac_f32 v67, v88, v88
    v_add_f32 v66, v66, v89
    v_fmac_f32 v67, v89, v89
    v_add_f32 v66, v66, v90
    v_fmac_f32 v67, v90, v90
    v_add_f32 v66, v66, v91
    v_fmac_f32 v67, v91, v91
    v_add_f32 v66, v66, v92
    v_fmac_f32 v67, v92, v92
    v_add_f32 v66, v66, v93
    v_fmac_f32 v67, v93, v93
    v_add_f32 v66, v66, v94
    v_fmac_f32 v67, v94, v94
    v_add_f32 v66, v66, v95
    v_fmac_f32 v67, v95, v95
    v_mov_b32 v68, v66
    v_mov_b32 v69, v67
    s_nop 1
    v_permlane32_swap_b32 v66, v68
    v_permlane32_swap_b32 v67, v69
    s_nop 1
    v_add_f32 v66, v66, v68
    v_add_f32 v67, v67, v69
    s_mov_b64 exec, 0xffffffff
    buffer_store_dwordx2 v[66:67], v64, s[12:15], s58 offen sc1
    s_mov_b64 exec, -1
    s_lshr_b32 s58, s50, 1
    s_lshl_b32 s58, s58, 7
    s_and_b32 s59, s50, 1
    s_lshl_b32 s59, s59, 3
    s_add_u32 s59, s59, s51
    s_add_u32 s72, s58, s59
    s_add_u32 s72, s72, 36700160
    s_and_b32 s34, s2, 7
    s_lshr_b32 s35, s2, 3
    s_and_b32 s24, s34, 1
    s_lshl_b32 s24, s24, 3
    s_lshr_b32 s25, s34, 1
    s_lshl_b32 s25, s25, 2
    s_and_b32 s34, s35, 7
    s_add_u32 s24, s24, s34
    s_lshr_b32 s35, s35, 3
    s_add_u32 s25, s25, s35
    s_lshl_b32 s27, s24, 2
    s_add_u32 s27, s27, s70
    s_mul_i32 s28, s70, 6144
    s_lshl_b32 s32, s70, 10
    s_mul_i32 s36, s25, 229376
    s_add_u32 s36, s36, 29360128
    s_mul_i32 s31, s70, 7168
    s_lshl_b32 s29, s31, 1
    s_add_u32 s31, s31, s36
    s_add_u32 s29, s29, s36
    s_lshl_b32 s30, s27, 15
    s_add_u32 s30, s30, 10485760
    s_lshl_b32 s73, s24, 7
    s_add_u32 s73, s73, 36700160
    s_add_u32 m0, s28, 0
    s_add_u32 s41, s29, 0
    buffer_load_dwordx4 v253, s[12:15], s41 offen offset:0 lds
    s_add_u32 m0, s28, 0
    s_add_u32 s41, s29, 0
    buffer_load_dwordx4 v253, s[12:15], s41 offen offset:1024 lds
    s_add_u32 m0, s28, 0
    s_add_u32 s41, s29, 0
    buffer_load_dwordx4 v253, s[12:15], s41 offen offset:2048 lds
    s_add_u32 m0, s28, 3072
    s_add_u32 s41, s29, 7168
    buffer_load_dwordx4 v253, s[12:15], s41 offen offset:0 lds
    s_waitcnt vmcnt(4)
    s_barrier
    s_cmp_lg_u32 s70, 0
    s_cbranch_scc1 blk1_kernel_sig_1
    v_mov_b32 v254, 0
    v_mov_b32 v255, 1
    s_mov_b64 exec, 1
    s_and_b32 s72, s72, 0xffffff80
    buffer_atomic_add v255, v254, s[12:15], s72 offen sc1
    s_mov_b64 exec, -1
blk1_kernel_sig_1:
    v_add_f32 v196, v196, v197
    v_add_f32 v198, v198, v199
    v_add_f32 v200, v200, v201
    v_add_f32 v202, v202, v203
    v_add_f32 v204, v204, v205
    v_add_f32 v206, v206, v207
    v_add_f32 v208, v208, v209
    v_add_f32 v210, v210, v211
    v_add_f32 v212, v212, v213
    v_add_f32 v214, v214, v215
    v_add_f32 v216, v216, v217
    v_add_f32 v218, v218, v219
    v_add_f32 v196, v196, v198
    v_add_f32 v200, v200, v202
    v_add_f32 v204, v204, v206
    v_add_f32 v208, v208, v210
    v_add_f32 v212, v212, v214
    v_add_f32 v216, v216, v218
    v_add_f32 v196, v196, v200
    v_add_f32 v204, v204, v208
    v_add_f32 v212, v212, v216
    v_add_f32 v196, v196, v204
    v_lshlrev_b32 v220, 2, v220
    v_add_u32 v220, 155648, v220
    ds_write_b32 v220, v196
    ds_write_b32 v220, v212 offset:1024
    v_and_b32 v232, 31, v252
    v_lshrrev_b32 v233, 5, v252
    v_lshlrev_b32 v234, 11, v233
    v_lshl_add_u32 v234, v232, 3, v234
    v_lshlrev_b32 v235, 2, v232
    s_lshl_b32 s34, s27, 12
    s_add_u32 s34, s34, 6356992
    v_lshlrev_b32 v237, 4, v233
    v_add_u32 v237, 155648, v237
    v_mov_b32 v229, v253
    v_add_u32 v230, 49152, v253
    v_add_u32 v231, 98304, v253
    s_mul_i32 s37, s27, 114688
    s_add_u32 s37, s37, 16777216
    s_mul_i32 s38, s25, 3072
    s_add_u32 s38, s38, s37
    s_add_u32 s38, s38, 65536
    s_lshl_b32 s43, s25, 12
    s_add_u32 s37, s37, s43
    s_lshl_b32 s40, s24, 7
    s_add_u32 s40, s40, s25
    s_add_u32 s40, s40, 36704256
    s_lshl_b32 s39, s27, 7
    s_add_u32 s39, s39, 7864320
    s_mov_b32 s42, 41943040
    s_cmp_eq_u32 s25, 0
    s_cselect_b32 s39, s39, s42
    s_add_u32 m0, s28, 3072
    s_add_u32 s41, s29, 7168
    buffer_load_dwordx4 v253, s[12:15], s41 offen offset:1024 lds
    s_add_u32 m0, s28, 3072
    s_add_u32 s41, s29, 7168
    buffer_load_dwordx4 v253, s[12:15], s41 offen offset:2048 lds
    s_add_u32 m0, s28, 24576
    s_add_u32 s41, s29, 57344
    buffer_load_dwordx4 v253, s[12:15], s41 offen offset:0 lds
    s_add_u32 m0, s28, 24576
    s_add_u32 s41, s29, 57344
    buffer_load_dwordx4 v253, s[12:15], s41 offen offset:1024 lds
    s_add_u32 m0, s28, 24576
    s_add_u32 s41, s29, 57344
    buffer_load_dwordx4 v253, s[12:15], s41 offen offset:2048 lds
    s_add_u32 m0, s28, 27648
    s_add_u32 s41, s29, 64512
    buffer_load_dwordx4 v253, s[12:15], s41 offen offset:0 lds
    s_add_u32 m0, s28, 27648
    s_add_u32 s41, s29, 64512
    buffer_load_dwordx4 v253, s[12:15], s41 offen offset:1024 lds
    s_add_u32 m0, s28, 27648
    s_add_u32 s41, s29, 64512
    buffer_load_dwordx4 v253, s[12:15], s41 offen offset:2048 lds
    s_add_u32 m0, s28, 49152
    s_add_u32 s41, s29, 114688
    buffer_load_dwordx4 v253, s[12:15], s41 offen offset:0 lds
    s_add_u32 m0, s28, 49152
    s_add_u32 s41, s29, 114688
    buffer_load_dwordx4 v253, s[12:15], s41 offen offset:1024 lds
    s_add_u32 m0, s28, 49152
    s_add_u32 s41, s29, 114688
    buffer_load_dwordx4 v253, s[12:15], s41 offen offset:2048 lds
    s_add_u32 m0, s28, 52224
    s_add_u32 s41, s29, 121856
    buffer_load_dwordx4 v253, s[12:15], s41 offen offset:0 lds
    s_add_u32 m0, s28, 52224
    s_add_u32 s41, s29, 121856
    buffer_load_dwordx4 v253, s[12:15], s41 offen offset:1024 lds
    s_add_u32 m0, s28, 52224
    s_add_u32 s41, s29, 121856
    buffer_load_dwordx4 v253, s[12:15], s41 offen offset:2048 lds
    s_waitcnt vmcnt(12) lgkmcnt(0)
    s_cmp_lg_u32 s70, 0
    s_cbranch_scc1 blk1_kernel_pok_3
    s_add_u32 s66, s8, s73
    s_addc_u32 s67, s9, 0
    s_mov_b32 s74, 0
blk1_kernel_poll_2:
    s_load_dword s16, s[66:67], 0 glc
    s_add_u32 s74, s74, 1
    s_waitcnt lgkmcnt(0)
    s_cmp_eq_u32 s16, 16
    s_cbranch_scc1 blk1_kernel_pok_3
    s_sleep 2
    s_cmp_lt_u32 s74, 0x40000
    s_cbranch_scc1 blk1_kernel_poll_2
blk1_kernel_pok_3:
    s_barrier
    s_mov_b32 s72, s40
    buffer_load_dwordx4 a[0:3], v253, s[12:15], s30 offen offset:0 sc1
    buffer_load_dwordx4 a[4:7], v253, s[12:15], s30 offen offset:1024 sc1
    buffer_load_dwordx4 a[8:11], v253, s[12:15], s30 offen offset:2048 sc1
    buffer_load_dwordx4 a[12:15], v253, s[12:15], s30 offen offset:3072 sc1
    s_add_u32 s30, s30, 4096
    buffer_load_dwordx4 a[16:19], v253, s[12:15], s30 offen offset:0 sc1
    buffer_load_dwordx4 a[20:23], v253, s[12:15], s30 offen offset:1024 sc1
    buffer_load_dwordx4 a[24:27], v253, s[12:15], s30 offen offset:2048 sc1
    buffer_load_dwordx4 a[28:31], v253, s[12:15], s30 offen offset:3072 sc1
    s_add_u32 s30, s30, 4096
    buffer_load_dwordx4 a[32:35], v253, s[12:15], s30 offen offset:0 sc1
    buffer_load_dwordx4 a[36:39], v253, s[12:15], s30 offen offset:1024 sc1
    buffer_load_dwordx4 a[40:43], v253, s[12:15], s30 offen offset:2048 sc1
    buffer_load_dwordx4 a[44:47], v253, s[12:15], s30 offen offset:3072 sc1
    s_add_u32 s30, s30, 4096
    buffer_load_dwordx4 a[48:51], v253, s[12:15], s30 offen offset:0 sc1
    ds_read_b128 v[112:115], v229 offset:0
    ds_read_b128 v[116:119], v229 offset:1024
    ds_read_b128 v[120:123], v229 offset:2048
    ds_read_b128 v[124:127], v229 offset:3072
    ds_read_b128 v[128:131], v229 offset:4096
    ds_read_b128 v[132:135], v229 offset:5120
    ds_read_b128 v[136:139], v229 offset:6144
    s_waitcnt vmcnt(12) lgkmcnt(5)
    v_mfma_f32_32x32x16_bf16 v[0:15], v[112:115], a[0:3], 0
    ds_read_b128 v[140:143], v229 offset:7168
    v_mfma_f32_32x32x16_bf16 v[16:31], v[116:119], a[0:3], 0
    buffer_load_dwordx4 a[52:55], v253, s[12:15], s30 offen offset:1024 sc1
    ds_read_b128 v[144:147], v229 offset:8192
    s_waitcnt lgkmcnt(5)
    v_mfma_f32_32x32x16_bf16 v[32:47], v[120:123], a[0:3], 0
    s_add_u32 m0, s28, 73728
    s_add_u32 s41, s29, 172032
    buffer_load_dwordx4 v253, s[12:15], s41 offen offset:0 lds
    ds_read_b128 v[112:115], v229 offset:9216
    s_waitcnt vmcnt(13)
    v_mfma_f32_32x32x16_bf16 v[0:15], v[124:127], a[4:7], v[0:15]
    ds_read_b128 v[116:119], v229 offset:10240
    s_waitcnt lgkmcnt(5)
    v_mfma_f32_32x32x16_bf16 v[16:31], v[128:131], a[4:7], v[16:31]
    buffer_load_dwordx4 a[56:59], v253, s[12:15], s30 offen offset:2048 sc1
    ds_read_b128 v[120:123], v229 offset:11264
    v_mfma_f32_32x32x16_bf16 v[32:47], v[132:135], a[4:7], v[32:47]
    s_add_u32 m0, s28, 73728
    s_add_u32 s41, s29, 172032
    buffer_load_dwordx4 v253, s[12:15], s41 offen offset:1024 lds
    ds_read_b128 v[124:127], v229 offset:12288
    s_waitcnt vmcnt(14) lgkmcnt(5)
    v_mfma_f32_32x32x16_bf16 v[0:15], v[136:139], a[8:11], v[0:15]
    ds_read_b128 v[128:131], v229 offset:13312
    v_mfma_f32_32x32x16_bf16 v[16:31], v[140:143], a[8:11], v[16:31]
    buffer_load_dwordx4 a[60:63], v253, s[12:15], s30 offen offset:3072 sc1
    s_add_u32 s30, s30, 4096
    ds_read_b128 v[132:135], v229 offset:14336
    s_waitcnt lgkmcnt(5)
    v_mfma_f32_32x32x16_bf16 v[32:47], v[144:147], a[8:11], v[32:47]
    s_add_u32 m0, s28, 73728
    s_add_u32 s41, s29, 172032
    buffer_load_dwordx4 v253, s[12:15], s41 offen offset:2048 lds
    ds_read_b128 v[136:139], v229 offset:15360
    s_waitcnt vmcnt(15)
    v_mfma_f32_32x32x16_bf16 v[0:15], v[112:115], a[12:15], v[0:15]
    ds_read_b128 v[140:143], v229 offset:16384
    s_waitcnt lgkmcnt(5)
    v_mfma_f32_32x32x16_bf16 v[16:31], v[116:119], a[12:15], v[16:31]
    buffer_load_dwordx4 a[64:67], v253, s[12:15], s30 offen offset:0 sc1
    ds_read_b128 v[144:147], v229 offset:17408
    v_mfma_f32_32x32x16_bf16 v[32:47], v[120:123], a[12:15], v[32:47]
    s_add_u32 m0, s28, 76800
    s_add_u32 s41, s29, 179200
    buffer_load_dwordx4 v253, s[12:15], s41 offen offset:0 lds
    ds_read_b128 v[112:115], v229 offset:18432
    s_waitcnt vmcnt(16) lgkmcnt(5)
    v_mfma_f32_32x32x16_bf16 v[0:15], v[124:127], a[16:19], v[0:15]
    ds_read_b128 v[116:119], v229 offset:19456
    v_mfma_f32_32x32x16_bf16 v[16:31], v[128:131], a[16:19], v[16:31]
    buffer_load_dwordx4 a[68:71], v253, s[12:15], s30 offen offset:1024 sc1
    ds_read_b128 v[120:123], v229 offset:20480
    s_waitcnt lgkmcnt(5)
    v_mfma_f32_32x32x16_bf16 v[32:47], v[132:135], a[16:19], v[32:47]
    s_add_u32 m0, s28, 76800
    s_add_u32 s41, s29, 179200
    buffer_load_dwordx4 v253, s[12:15], s41 offen offset:1024 lds
    ds_read_b128 v[124:127], v229 offset:21504
    s_waitcnt vmcnt(17)
    v_mfma_f32_32x32x16_bf16 v[0:15], v[136:139], a[20:23], v[0:15]
    ds_read_b128 v[128:131], v229 offset:22528
    s_waitcnt lgkmcnt(5)
    v_mfma_f32_32x32x16_bf16 v[16:31], v[140:143], a[20:23], v[16:31]
    buffer_load_dwordx4 a[72:75], v253, s[12:15], s30 offen offset:2048 sc1
    ds_read_b128 v[132:135], v229 offset:23552
    v_mfma_f32_32x32x16_bf16 v[32:47], v[144:147], a[20:23], v[32:47]
    s_add_u32 m0, s28, 76800
    s_add_u32 s41, s29, 179200
    buffer_load_dwordx4 v253, s[12:15], s41 offen offset:2048 lds
    s_waitcnt vmcnt(31)
    s_barrier
    ds_read_b128 v[136:139], v229 offset:24576
    s_waitcnt vmcnt(18) lgkmcnt(5)
    v_mfma_f32_32x32x16_bf16 v[0:15], v[112:115], a[24:27], v[0:15]
    ds_read_b128 v[140:143], v229 offset:25600
    v_mfma_f32_32x32x16_bf16 v[16:31], v[116:119], a[24:27], v[16:31]
    buffer_load_dwordx4 a[76:79], v253, s[12:15], s30 offen offset:3072 sc1
    s_add_u32 s30, s30, 4096
    ds_read_b128 v[144:147], v229 offset:26624
    s_waitcnt lgkmcnt(5)
    v_mfma_f32_32x32x16_bf16 v[32:47], v[120:123], a[24:27], v[32:47]
    buffer_load_dwordx2 v[180:181], v234, s[12:15], s34 offen offset:0 sc1
    ds_read_b128 v[112:115], v229 offset:27648
    s_waitcnt vmcnt(19)
    v_mfma_f32_32x32x16_bf16 v[0:15], v[124:127], a[28:31], v[0:15]
    ds_read_b128 v[116:119], v229 offset:28672
    s_waitcnt lgkmcnt(5)
    v_mfma_f32_32x32x16_bf16 v[16:31], v[128:131], a[28:31], v[16:31]
    buffer_load_dwordx4 a[80:83], v253, s[12:15], s30 offen offset:0 sc1
    ds_read_b128 v[120:123], v229 offset:29696
    v_mfma_f32_32x32x16_bf16 v[32:47], v[132:135], a[28:31], v[32:47]
    buffer_load_dwordx2 v[182:183], v234, s[12:15], s34 offen offset:256 sc1
    ds_read_b128 v[124:127], v229 offset:30720
    s_waitcnt vmcnt(20) lgkmcnt(5)
    v_mfma_f32_32x32x16_bf16 v[0:15], v[136:139], a[32:35], v[0:15]
    ds_read_b128 v[128:131], v229 offset:31744
    v_mfma_f32_32x32x16_bf16 v[16:31], v[140:143], a[32:35], v[16:31]
    buffer_load_dwordx4 a[84:87], v253, s[12:15], s30 offen offset:1024 sc1
    ds_read_b128 v[132:135], v229 offset:32768
    s_waitcnt lgkmcnt(5)
    v_mfma_f32_32x32x16_bf16 v[32:47], v[144:147], a[32:35], v[32:47]
    buffer_load_dwordx2 v[184:185], v234, s[12:15], s34 offen offset:512 sc1
    ds_read_b128 v[136:139], v229 offset:33792
    s_waitcnt vmcnt(21)
    v_mfma_f32_32x32x16_bf16 v[0:15], v[112:115], a[36:39], v[0:15]
    ds_read_b128 v[140:143], v229 offset:34816
    s_waitcnt lgkmcnt(5)
    v_mfma_f32_32x32x16_bf16 v[16:31], v[116:119], a[36:39], v[16:31]
    buffer_load_dwordx4 a[88:91], v253, s[12:15], s30 offen offset:2048 sc1
    ds_read_b128 v[144:147], v229 offset:35840
    v_mfma_f32_32x32x16_bf16 v[32:47], v[120:123], a[36:39], v[32:47]
    buffer_load_dwordx2 v[186:187], v234, s[12:15], s34 offen offset:768 sc1
    ds_read_b128 v[112:115], v229 offset:36864
    s_waitcnt vmcnt(22) lgkmcnt(5)
    v_mfma_f32_32x32x16_bf16 v[0:15], v[124:127], a[40:43], v[0:15]
    ds_read_b128 v[116:119], v229 offset:37888
    v_mfma_f32_32x32x16_bf16 v[16:31], v[128:131], a[40:43], v[16:31]
    buffer_load_dwordx4 a[92:95], v253, s[12:15], s30 offen offset:3072 sc1
    s_add_u32 s30, s30, 4096
    ds_read_b128 v[120:123], v229 offset:38912
    s_waitcnt lgkmcnt(5)
    v_mfma_f32_32x32x16_bf16 v[32:47], v[132:135], a[40:43], v[32:47]
    buffer_load_dwordx2 v[188:189], v234, s[12:15], s34 offen offset:1024 sc1
    ds_read_b128 v[124:127], v229 offset:39936
    s_waitcnt vmcnt(23)
    v_mfma_f32_32x32x16_bf16 v[0:15], v[136:139], a[44:47], v[0:15]
    ds_read_b128 v[128:131], v229 offset:40960
    s_waitcnt lgkmcnt(5)
    v_mfma_f32_32x32x16_bf16 v[16:31], v[140:143], a[44:47], v[16:31]
    buffer_load_dwordx4 a[96:99], v253, s[12:15], s30 offen offset:0 sc1
    ds_read_b128 v[132:135], v229 offset:41984
    v_mfma_f32_32x32x16_bf16 v[32:47], v[144:147], a[44:47], v[32:47]
    buffer_load_dwordx2 v[190:191], v234, s[12:15], s34 offen offset:1280 sc1
    ds_read_b128 v[136:139], v229 offset:43008
    s_waitcnt vmcnt(24) lgkmcnt(5)
    v_mfma_f32_32x32x16_bf16 v[0:15], v[112:115], a[48:51], v[0:15]
    ds_read_b128 v[140:143], v229 offset:44032
    v_mfma_f32_32x32x16_bf16 v[16:31], v[116:119], a[48:51], v[16:31]
    buffer_load_dwordx4 a[100:103], v253, s[12:15], s30 offen offset:1024 sc1
    ds_read_b128 v[144:147], v229 offset:45056
    s_waitcnt lgkmcnt(5)
    v_mfma_f32_32x32x16_bf16 v[32:47], v[120:123], a[48:51], v[32:47]
    buffer_load_dwordx2 v[192:193], v234, s[12:15], s34 offen offset:1536 sc1
    ds_read_b128 v[112:115], v229 offset:46080
    s_waitcnt vmcnt(25)
    v_mfma_f32_32x32x16_bf16 v[0:15], v[124:127], a[52:55], v[0:15]
    ds_read_b128 v[116:119], v229 offset:47104
    s_waitcnt lgkmcnt(5)
    v_mfma_f32_32x32x16_bf16 v[16:31], v[128:131], a[52:55], v[16:31]
    buffer_load_dwordx4 a[104:107], v253, s[12:15], s30 offen offset:2048 sc1
    ds_read_b128 v[120:123], v229 offset:48128
    v_mfma_f32_32x32x16_bf16 v[32:47], v[132:135], a[52:55], v[32:47]
    buffer_load_dwordx2 v[194:195], v234, s[12:15], s34 offen offset:1792 sc1
    s_waitcnt vmcnt(41)
    s_barrier
    ds_read_b128 v[124:127], v230 offset:0
    s_waitcnt vmcnt(25) lgkmcnt(5)
    v_mfma_f32_32x32x16_bf16 v[0:15], v[136:139], a[56:59], v[0:15]
    ds_read_b128 v[128:131], v230 offset:1024
    v_mfma_f32_32x32x16_bf16 v[16:31], v[140:143], a[56:59], v[16:31]
    buffer_load_dwordx4 a[108:111], v253, s[12:15], s30 offen offset:3072 sc1
    s_add_u32 s30, s30, 4096
    ds_read_b128 v[132:135], v230 offset:2048
    s_waitcnt lgkmcnt(5)
    v_mfma_f32_32x32x16_bf16 v[32:47], v[144:147], a[56:59], v[32:47]
    ds_read_b128 v[136:139], v230 offset:3072
    s_waitcnt vmcnt(24)
    v_mfma_f32_32x32x16_bf16 v[0:15], v[112:115], a[60:63], v[0:15]
    ds_read_b128 v[140:143], v230 offset:4096
    s_waitcnt lgkmcnt(5)
    v_mfma_f32_32x32x16_bf16 v[16:31], v[116:119], a[60:63], v[16:31]
    buffer_load_dwordx4 a[112:115], v253, s[12:15], s30 offen offset:0 sc1
    ds_read_b128 v[144:147], v230 offset:5120
    v_mfma_f32_32x32x16_bf16 v[32:47], v[120:123], a[60:63], v[32:47]
    ds_read_b128 v[112:115], v230 offset:6144
    s_waitcnt vmcnt(23) lgkmcnt(5)
    v_mfma_f32_32x32x16_bf16 v[0:15], v[124:127], a[64:67], v[0:15]
    ds_read_b128 v[116:119], v230 offset:7168
    v_mfma_f32_32x32x16_bf16 v[16:31], v[128:131], a[64:67], v[16:31]
    buffer_load_dwordx4 a[116:119], v253, s[12:15], s30 offen offset:1024 sc1
    ds_read_b128 v[120:123], v230 offset:8192
    s_waitcnt lgkmcnt(5)
    v_mfma_f32_32x32x16_bf16 v[32:47], v[132:135], a[64:67], v[32:47]
    ds_read_b128 v[124:127], v230 offset:9216
    s_waitcnt vmcnt(22)
    v_mfma_f32_32x32x16_bf16 v[0:15], v[136:139], a[68:71], v[0:15]
    ds_read_b128 v[128:131], v230 offset:10240
    s_waitcnt lgkmcnt(5)
    v_mfma_f32_32x32x16_bf16 v[16:31], v[140:143], a[68:71], v[16:31]
    buffer_load_dwordx4 a[120:123], v253, s[12:15], s30 offen offset:2048 sc1
    ds_read_b128 v[132:135], v230 offset:11264
    v_mfma_f32_32x32x16_bf16 v[32:47], v[144:147], a[68:71], v[32:47]
    ds_read_b128 v[136:139], v230 offset:12288
    s_waitcnt vmcnt(21) lgkmcnt(5)
    v_mfma_f32_32x32x16_bf16 v[0:15], v[112:115], a[72:75], v[0:15]
    ds_read_b128 v[140:143], v230 offset:13312
    v_mfma_f32_32x32x16_bf16 v[16:31], v[116:119], a[72:75], v[16:31]
    buffer_load_dwordx4 a[124:127], v253, s[12:15], s30 offen offset:3072 sc1
    s_add_u32 s30, s30, 4096
    ds_read_b128 v[144:147], v230 offset:14336
    s_waitcnt lgkmcnt(5)
    v_mfma_f32_32x32x16_bf16 v[32:47], v[120:123], a[72:75], v[32:47]
    s_add_u32 m0, s32, 98304
    s_add_u32 s41, s31, 3072
    buffer_load_dwordx4 v253, s[12:15], s41 offen lds
    ds_read_b128 v[112:115], v230 offset:15360
    s_waitcnt vmcnt(21)
    v_mfma_f32_32x32x16_bf16 v[0:15], v[124:127], a[76:79], v[0:15]
    ds_read_b128 v[116:119], v230 offset:16384
    s_waitcnt lgkmcnt(5)
    v_mfma_f32_32x32x16_bf16 v[16:31], v[128:131], a[76:79], v[16:31]
    s_add_u32 m0, s32, 102400
    s_add_u32 s41, s31, 31744
    buffer_load_dwordx4 v253, s[12:15], s41 offen lds
    ds_read_b128 v[120:123], v230 offset:17408
    v_mfma_f32_32x32x16_bf16 v[32:47], v[132:135], a[76:79], v[32:47]
    ds_read_b128 v[124:127], v230 offset:18432
    s_waitcnt vmcnt(20) lgkmcnt(5)
    v_mfma_f32_32x32x16_bf16 v[0:15], v[136:139], a[80:83], v[0:15]
    s_add_u32 m0, s32, 106496
    s_add_u32 s41, s31, 60416
    buffer_load_dwordx4 v253, s[12:15], s41 offen lds
    ds_read_b128 v[128:131], v230 offset:19456
    v_mfma_f32_32x32x16_bf16 v[16:31], v[140:143], a[80:83], v[16:31]
    ds_read_b128 v[132:135], v230 offset:20480
    s_waitcnt lgkmcnt(5)
    v_mfma_f32_32x32x16_bf16 v[32:47], v[144:147], a[80:83], v[32:47]
    s_add_u32 m0, s32, 110592
    s_add_u32 s41, s31, 89088
    buffer_load_dwordx4 v253, s[12:15], s41 offen lds
    ds_read_b128 v[136:139], v230 offset:21504
    s_waitcnt vmcnt(20)
    v_mfma_f32_32x32x16_bf16 v[0:15], v[112:115], a[84:87], v[0:15]
    ds_read_b128 v[140:143], v230 offset:22528
    s_waitcnt lgkmcnt(5)
    v_mfma_f32_32x32x16_bf16 v[16:31], v[116:119], a[84:87], v[16:31]
    s_add_u32 m0, s32, 114688
    s_add_u32 s41, s31, 117760
    buffer_load_dwordx4 v253, s[12:15], s41 offen lds
    ds_read_b128 v[144:147], v230 offset:23552
    v_mfma_f32_32x32x16_bf16 v[32:47], v[120:123], a[84:87], v[32:47]
    s_waitcnt vmcnt(26)
    s_barrier
    ds_read_b128 v[112:115], v230 offset:24576
    s_waitcnt vmcnt(10) lgkmcnt(5)
    v_mfma_f32_32x32x16_bf16 v[0:15], v[124:127], a[88:91], v[0:15]
    s_add_u32 m0, s32, 118784
    s_add_u32 s41, s31, 146432
    buffer_load_dwordx4 v253, s[12:15], s41 offen lds
    v_add_f32 v180, v180, v182
    v_add_f32 v181, v181, v183
    ds_read_b128 v[116:119], v230 offset:25600
    v_mfma_f32_32x32x16_bf16 v[16:31], v[128:131], a[88:91], v[16:31]
    v_add_f32 v184, v184, v186
    v_add_f32 v185, v185, v187
    ds_read_b128 v[120:123], v230 offset:26624
    s_waitcnt lgkmcnt(5)
    v_mfma_f32_32x32x16_bf16 v[32:47], v[132:135], a[88:91], v[32:47]
    s_add_u32 m0, s32, 122880
    s_add_u32 s41, s31, 175104
    buffer_load_dwordx4 v253, s[12:15], s41 offen lds
    v_add_f32 v180, v180, v184
    v_add_f32 v181, v181, v185
    ds_read_b128 v[124:127], v230 offset:27648
    s_waitcnt vmcnt(19)
    v_mfma_f32_32x32x16_bf16 v[0:15], v[136:139], a[92:95], v[0:15]
    v_add_f32 v188, v188, v190
    v_add_f32 v189, v189, v191
    ds_read_b128 v[128:131], v230 offset:28672
    s_waitcnt lgkmcnt(5)
    v_mfma_f32_32x32x16_bf16 v[16:31], v[140:143], a[92:95], v[16:31]
    s_add_u32 m0, s32, 126976
    s_add_u32 s41, s31, 203776
    buffer_load_dwordx4 v253, s[12:15], s41 offen lds
    v_add_f32 v192, v192, v194
    v_add_f32 v193, v193, v195
    ds_read_b128 v[132:135], v230 offset:29696
    v_mfma_f32_32x32x16_bf16 v[32:47], v[144:147], a[92:95], v[32:47]
    v_add_f32 v188, v188, v192
    v_add_f32 v189, v189, v193
    ds_read_b128 v[136:139], v230 offset:30720
    s_waitcnt vmcnt(18) lgkmcnt(5)
    v_mfma_f32_32x32x16_bf16 v[0:15], v[112:115], a[96:99], v[0:15]
    s_add_u32 m0, s32, 0
    s_add_u32 s41, s31, 4096
    buffer_load_dwordx4 v253, s[12:15], s41 offen lds
    v_cvt_f64_f32 v[238:239], v180
    v_cvt_f64_f32 v[240:241], v181
    ds_read_b128 v[140:143], v230 offset:31744
    v_mfma_f32_32x32x16_bf16 v[16:31], v[116:119], a[96:99], v[16:31]
    v_cvt_f64_f32 v[242:243], v188
    v_cvt_f64_f32 v[244:245], v189
    ds_read_b128 v[144:147], v230 offset:32768
    s_waitcnt lgkmcnt(5)
    v_mfma_f32_32x32x16_bf16 v[32:47], v[120:123], a[96:99], v[32:47]
    v_add_f64 v[238:239], v[238:239], v[242:243]
    v_add_f64 v[240:241], v[240:241], v[244:245]
    ds_read_b128 v[112:115], v230 offset:33792
    s_waitcnt vmcnt(17)
    v_mfma_f32_32x32x16_bf16 v[0:15], v[124:127], a[100:103], v[0:15]
    s_add_u32 m0, s32, 4096
    s_add_u32 s41, s31, 32768
    buffer_load_dwordx4 v253, s[12:15], s41 offen lds
    v_mov_b32 v242, v238
    v_mov_b32 v243, v239
    ds_read_b128 v[116:119], v230 offset:34816
    s_waitcnt lgkmcnt(5)
    v_mfma_f32_32x32x16_bf16 v[16:31], v[128:131], a[100:103], v[16:31]
    v_mov_b32 v244, v240
    v_mov_b32 v245, v241
    ds_read_b128 v[120:123], v230 offset:35840
    v_mfma_f32_32x32x16_bf16 v[32:47], v[132:135], a[100:103], v[32:47]
    s_nop 1
    v_permlane32_swap_b32 v238, v242
    ds_read_b128 v[124:127], v230 offset:36864
    s_waitcnt vmcnt(16) lgkmcnt(5)
    v_mfma_f32_32x32x16_bf16 v[0:15], v[136:139], a[104:107], v[0:15]
    s_add_u32 m0, s32, 8192
    s_add_u32 s41, s31, 61440
    buffer_load_dwordx4 v253, s[12:15], s41 offen lds
    v_permlane32_swap_b32 v239, v243
    v_permlane32_swap_b32 v240, v244
    ds_read_b128 v[128:131], v230 offset:37888
    v_mfma_f32_32x32x16_bf16 v[16:31], v[140:143], a[104:107], v[16:31]
    v_permlane32_swap_b32 v241, v245
    s_nop 1
    ds_read_b128 v[132:135], v230 offset:38912
    s_waitcnt lgkmcnt(5)
    v_mfma_f32_32x32x16_bf16 v[32:47], v[144:147], a[104:107], v[32:47]
    v_add_f64 v[238:239], v[238:239], v[242:243]
    v_add_f64 v[240:241], v[240:241], v[244:245]
    ds_read_b128 v[136:139], v230 offset:39936
    s_waitcnt vmcnt(15)
    v_mfma_f32_32x32x16_bf16 v[0:15], v[112:115], a[108:111], v[0:15]
    s_add_u32 m0, s32, 12288
    s_add_u32 s41, s31, 90112
    buffer_load_dwordx4 v253, s[12:15], s41 offen lds
    v_ldexp_f64 v[238:239], v[238:239], -9
    v_ldexp_f64 v[240:241], v[240:241], -9
    ds_read_b128 v[140:143], v230 offset:40960
    ds_read_b128 v[148:151], v237 offset:384
    ds_read_b128 v[152:155], v237 offset:416
    ds_read_b128 v[156:159], v237 offset:448
    ds_read_b128 v[160:163], v237 offset:480
    s_waitcnt lgkmcnt(9)
    v_mfma_f32_32x32x16_bf16 v[16:31], v[116:119], a[108:111], v[16:31]
    v_fma_f64 v[240:241], -v[238:239], v[238:239], v[240:241]
    v_cvt_f32_f64 v246, v[238:239]
    ds_read_b128 v[144:147], v230 offset:41984
    v_mfma_f32_32x32x16_bf16 v[32:47], v[120:123], a[108:111], v[32:47]
    v_cvt_f32_f64 v247, v[240:241]
    v_max_f32 v247, 0, v247
    ds_read_b128 v[112:115], v230 offset:43008
    s_waitcnt vmcnt(15) lgkmcnt(9)
    v_mfma_f32_32x32x16_bf16 v[0:15], v[124:127], a[112:115], v[0:15]
    s_add_u32 m0, s32, 16384
    s_add_u32 s41, s31, 118784
    buffer_load_dwordx4 v253, s[12:15], s41 offen lds
    v_add_f32 v247, 0x3727c5ac, v247
    v_rsq_f32 v247, v247
    ds_read_b128 v[116:119], v230 offset:44032
    v_mfma_f32_32x32x16_bf16 v[16:31], v[128:131], a[112:115], v[16:31]
    s_nop 0
    v_sub_f32 v248, 0, v246
    ds_read_b128 v[120:123], v230 offset:45056
    s_waitcnt lgkmcnt(9)
    v_mfma_f32_32x32x16_bf16 v[32:47], v[132:135], a[112:115], v[32:47]
    v_mul_f32 v250, v247, v247
    buffer_store_dword v250, v235, s[12:15], s39 offen sc1
    ds_read_b128 v[124:127], v230 offset:46080
    s_waitcnt vmcnt(16)
    v_mfma_f32_32x32x16_bf16 v[0:15], v[136:139], a[116:119], v[0:15]
    s_add_u32 m0, s32, 20480
    s_add_u32 s41, s31, 147456
    buffer_load_dwordx4 v253, s[12:15], s41 offen lds
    s_waitcnt lgkmcnt(5)
    v_mul_f32 v48, v248, v148
    v_mul_f32 v49, v248, v149
    v_mul_f32 v50, v248, v150
    ds_read_b128 v[128:131], v230 offset:47104
    s_waitcnt lgkmcnt(5)
    v_mfma_f32_32x32x16_bf16 v[16:31], v[140:143], a[116:119], v[16:31]
    v_mul_f32 v51, v248, v151
    v_mul_f32 v52, v248, v152
    v_mul_f32 v53, v248, v153
    ds_read_b128 v[132:135], v230 offset:48128
    v_mfma_f32_32x32x16_bf16 v[32:47], v[144:147], a[116:119], v[32:47]
    v_mul_f32 v54, v248, v154
    v_mul_f32 v55, v248, v155
    v_mul_f32 v56, v248, v156
    s_waitcnt vmcnt(7)
    s_barrier
    ds_read_b128 v[136:139], v231 offset:0
    s_waitcnt vmcnt(16) lgkmcnt(5)
    v_mfma_f32_32x32x16_bf16 v[0:15], v[112:115], a[120:123], v[0:15]
    s_add_u32 m0, s32, 24576
    s_add_u32 s41, s31, 176128
    buffer_load_dwordx4 v253, s[12:15], s41 offen lds
    v_mul_f32 v57, v248, v157
    v_mul_f32 v58, v248, v158
    v_mul_f32 v59, v248, v159
    ds_read_b128 v[140:143], v231 offset:1024
    v_mfma_f32_32x32x16_bf16 v[16:31], v[116:119], a[120:123], v[16:31]
    v_mul_f32 v60, v248, v160
    v_mul_f32 v61, v248, v161
    v_mul_f32 v62, v248, v162
    ds_read_b128 v[144:147], v231 offset:2048
    s_waitcnt lgkmcnt(5)
    v_mfma_f32_32x32x16_bf16 v[32:47], v[120:123], a[120:123], v[32:47]
    v_mul_f32 v63, v248, v163
    ds_read_b128 v[112:115], v231 offset:3072
    s_waitcnt vmcnt(16)
    v_mfma_f32_32x32x16_bf16 v[0:15], v[124:127], a[124:127], v[0:15]
    s_add_u32 m0, s32, 28672
    s_add_u32 s41, s31, 204800
    buffer_load_dwordx4 v253, s[12:15], s41 offen lds
    ds_read_b128 v[116:119], v231 offset:4096
    s_waitcnt lgkmcnt(5)
    v_mfma_f32_32x32x16_bf16 v[16:31], v[128:131], a[124:127], v[16:31]
    ds_read_b128 v[120:123], v231 offset:5120
    ds_read_b128 v[164:167], v237 offset:0
    ds_read_b128 v[168:171], v237 offset:32
    ds_read_b128 v[172:175], v237 offset:64
    ds_read_b128 v[176:179], v237 offset:96
    v_mfma_f32_32x32x16_bf16 v[32:47], v[132:135], a[124:127], v[32:47]
    ds_read_b128 v[124:127], v231 offset:6144
    s_waitcnt lgkmcnt(9)
    v_mfma_f32_32x32x16_bf16 v[48:63], v[136:139], a[0:3], v[48:63]
    s_add_u32 m0, s32, 32768
    s_add_u32 s41, s31, 5120
    buffer_load_dwordx4 v253, s[12:15], s41 offen lds
    ds_read_b128 v[128:131], v231 offset:7168
    v_mfma_f32_32x32x16_bf16 v[48:63], v[140:143], a[4:7], v[48:63]
    ds_read_b128 v[132:135], v231 offset:8192
    s_waitcnt lgkmcnt(9)
    v_mfma_f32_32x32x16_bf16 v[48:63], v[144:147], a[8:11], v[48:63]
    ds_read_b128 v[136:139], v231 offset:9216
    v_mfma_f32_32x32x16_bf16 v[48:63], v[112:115], a[12:15], v[48:63]
    s_add_u32 m0, s32, 36864
    s_add_u32 s41, s31, 33792
    buffer_load_dwordx4 v253, s[12:15], s41 offen lds
    s_waitcnt lgkmcnt(4)
    v_fmac_f32 v0, v248, v164
    v_fmac_f32 v1, v248, v165
    ds_read_b128 v[140:143], v231 offset:10240
    s_waitcnt lgkmcnt(9)
    v_mfma_f32_32x32x16_bf16 v[48:63], v[116:119], a[16:19], v[48:63]
    v_fmac_f32 v2, v248, v166
    v_fmac_f32 v3, v248, v167
    ds_read_b128 v[144:147], v231 offset:11264
    v_mfma_f32_32x32x16_bf16 v[48:63], v[120:123], a[20:23], v[48:63]
    v_fmac_f32 v4, v248, v168
    v_fmac_f32 v5, v248, v169
    ds_read_b128 v[112:115], v231 offset:12288
    s_waitcnt lgkmcnt(5)
    v_mfma_f32_32x32x16_bf16 v[48:63], v[124:127], a[24:27], v[48:63]
    s_add_u32 m0, s32, 40960
    s_add_u32 s41, s31, 62464
    buffer_load_dwordx4 v253, s[12:15], s41 offen lds
    v_fmac_f32 v6, v248, v170
    v_fmac_f32 v7, v248, v171
    ds_read_b128 v[116:119], v231 offset:13312
    v_mfma_f32_32x32x16_bf16 v[48:63], v[128:131], a[28:31], v[48:63]
    v_fmac_f32 v8, v248, v172
    v_fmac_f32 v9, v248, v173
    ds_read_b128 v[120:123], v231 offset:14336
    s_waitcnt lgkmcnt(5)
    v_mfma_f32_32x32x16_bf16 v[48:63], v[132:135], a[32:35], v[48:63]
    v_fmac_f32 v10, v248, v174
    v_fmac_f32 v11, v248, v175
    ds_read_b128 v[124:127], v231 offset:15360
    v_mfma_f32_32x32x16_bf16 v[48:63], v[136:139], a[36:39], v[48:63]
    s_add_u32 m0, s32, 45056
    s_add_u32 s41, s31, 91136
    buffer_load_dwordx4 v253, s[12:15], s41 offen lds
    v_fmac_f32 v12, v248, v176
    v_fmac_f32 v13, v248, v177
    ds_read_b128 v[128:131], v231 offset:16384
    s_waitcnt lgkmcnt(5)
    v_mfma_f32_32x32x16_bf16 v[48:63], v[140:143], a[40:43], v[48:63]
    v_fmac_f32 v14, v248, v178
    v_fmac_f32 v15, v248, v179
    ds_read_b128 v[132:135], v231 offset:17408
    v_mfma_f32_32x32x16_bf16 v[48:63], v[144:147], a[44:47], v[48:63]
    v_max_f32 v0, 0, v0
    v_max_f32 v1, 0, v1
    ds_read_b128 v[136:139], v231 offset:18432
    s_waitcnt lgkmcnt(5)
    v_mfma_f32_32x32x16_bf16 v[48:63], v[112:115], a[48:51], v[48:63]
    s_add_u32 m0, s32, 49152
    s_add_u32 s41, s31, 119808
    buffer_load_dwordx4 v253, s[12:15], s41 offen lds
    v_max_f32 v2, 0, v2
    v_max_f32 v3, 0, v3
    ds_read_b128 v[140:143], v231 offset:19456
    v_mfma_f32_32x32x16_bf16 v[48:63], v[116:119], a[52:55], v[48:63]
    v_max_f32 v4, 0, v4
    v_max_f32 v5, 0, v5
    ds_read_b128 v[144:147], v231 offset:20480
    s_waitcnt lgkmcnt(5)
    v_mfma_f32_32x32x16_bf16 v[48:63], v[120:123], a[56:59], v[48:63]
    v_max_f32 v6, 0, v6
    v_max_f32 v7, 0, v7
    ds_read_b128 v[112:115], v231 offset:21504
    v_mfma_f32_32x32x16_bf16 v[48:63], v[124:127], a[60:63], v[48:63]
    s_add_u32 m0, s32, 53248
    s_add_u32 s41, s31, 148480
    buffer_load_dwordx4 v253, s[12:15], s41 offen lds
    v_mul_f32 v0, v0, v8
    v_mul_f32 v1, v1, v9
    ds_read_b128 v[116:119], v231 offset:22528
    s_waitcnt lgkmcnt(5)
    v_mfma_f32_32x32x16_bf16 v[48:63], v[128:131], a[64:67], v[48:63]
    v_mul_f32 v2, v2, v10
    v_mul_f32 v3, v3, v11
    ds_read_b128 v[120:123], v231 offset:23552
    v_mfma_f32_32x32x16_bf16 v[48:63], v[132:135], a[68:71], v[48:63]
    v_mul_f32 v4, v4, v12
    v_mul_f32 v5, v5, v13
    ds_read_b128 v[124:127], v231 offset:24576
    ds_read_b128 v[148:151], v237 offset:512
    ds_read_b128 v[152:155], v237 offset:544
    ds_read_b128 v[156:159], v237 offset:576
    ds_read_b128 v[160:163], v237 offset:608
    ds_read_b128 v[164:167], v237 offset:128
    ds_read_b128 v[168:171], v237 offset:160
    ds_read_b128 v[172:175], v237 offset:192
    ds_read_b128 v[176:179], v237 offset:224
    s_waitcnt lgkmcnt(13)
    v_mfma_f32_32x32x16_bf16 v[48:63], v[136:139], a[72:75], v[48:63]
    s_add_u32 m0, s32, 57344
    s_add_u32 s41, s31, 177152
    buffer_load_dwordx4 v253, s[12:15], s41 offen lds
    v_mul_f32 v6, v6, v14
    v_mul_f32 v7, v7, v15
    ds_read_b128 v[128:131], v231 offset:25600
    v_mfma_f32_32x32x16_bf16 v[48:63], v[140:143], a[76:79], v[48:63]
    v_cvt_pk_bf16_f32 v8, v0, v1
    v_cvt_pk_bf16_f32 v9, v2, v3
    ds_read_b128 v[132:135], v231 offset:26624
    s_waitcnt lgkmcnt(13)
    v_mfma_f32_32x32x16_bf16 v[48:63], v[144:147], a[80:83], v[48:63]
    v_cvt_pk_bf16_f32 v10, v4, v5
    v_cvt_pk_bf16_f32 v11, v6, v7
    ds_read_b128 v[136:139], v231 offset:27648
    v_mfma_f32_32x32x16_bf16 v[48:63], v[112:115], a[84:87], v[48:63]
    s_add_u32 m0, s32, 61440
    s_add_u32 s41, s31, 205824
    buffer_load_dwordx4 v253, s[12:15], s41 offen lds
    buffer_store_dwordx4 v[8:11], v253, s[12:15], s37 offen offset:0 sc1
    ds_read_b128 v[140:143], v231 offset:28672
    s_waitcnt lgkmcnt(13)
    v_mfma_f32_32x32x16_bf16 v[48:63], v[116:119], a[88:91], v[48:63]
    s_waitcnt lgkmcnt(4)
    v_fmac_f32 v16, v248, v164
    v_fmac_f32 v17, v248, v165
    ds_read_b128 v[144:147], v231 offset:29696
    v_mfma_f32_32x32x16_bf16 v[48:63], v[120:123], a[92:95], v[48:63]
    s_waitcnt lgkmcnt(9)
    v_mul_f32 v64, v248, v148
    v_mul_f32 v65, v248, v149
    v_mul_f32 v66, v248, v150
    ds_read_b128 v[112:115], v231 offset:30720
    s_waitcnt lgkmcnt(5)
    v_mfma_f32_32x32x16_bf16 v[48:63], v[124:127], a[96:99], v[48:63]
    v_mul_f32 v67, v248, v151
    v_mul_f32 v68, v248, v152
    v_mul_f32 v69, v248, v153
    ds_read_b128 v[116:119], v231 offset:31744
    v_mfma_f32_32x32x16_bf16 v[48:63], v[128:131], a[100:103], v[48:63]
    v_mul_f32 v70, v248, v154
    v_mul_f32 v71, v248, v155
    v_mul_f32 v72, v248, v156
    s_waitcnt vmcnt(9)
    s_barrier
    ds_read_b128 v[120:123], v229 offset:0
    s_waitcnt lgkmcnt(5)
    v_mfma_f32_32x32x16_bf16 v[48:63], v[132:135], a[104:107], v[48:63]
    v_mul_f32 v73, v248, v157
    v_mul_f32 v74, v248, v158
    v_mul_f32 v75, v248, v159
    ds_read_b128 v[124:127], v229 offset:1024
    v_mfma_f32_32x32x16_bf16 v[48:63], v[136:139], a[108:111], v[48:63]
    s_add_u32 m0, s32, 65536
    s_add_u32 s41, s31, 6144
    buffer_load_dwordx4 v253, s[12:15], s41 offen lds
    v_mul_f32 v76, v248, v160
    v_mul_f32 v77, v248, v161
    v_mul_f32 v78, v248, v162
    ds_read_b128 v[128:131], v229 offset:2048
    s_waitcnt lgkmcnt(5)
    v_mfma_f32_32x32x16_bf16 v[48:63], v[140:143], a[112:115], v[48:63]
    v_mul_f32 v79, v248, v163
    ds_read_b128 v[132:135], v229 offset:3072
    v_mfma_f32_32x32x16_bf16 v[48:63], v[144:147], a[116:119], v[48:63]
    v_fmac_f32 v18, v248, v166
    v_fmac_f32 v19, v248, v167
    ds_read_b128 v[136:139], v229 offset:4096
    s_waitcnt lgkmcnt(5)
    v_mfma_f32_32x32x16_bf16 v[48:63], v[112:115], a[120:123], v[48:63]
    s_add_u32 m0, s32, 69632
    s_add_u32 s41, s31, 34816
    buffer_load_dwordx4 v253, s[12:15], s41 offen lds
    v_fmac_f32 v20, v248, v168
    v_fmac_f32 v21, v248, v169
    ds_read_b128 v[140:143], v229 offset:5120
    v_mfma_f32_32x32x16_bf16 v[48:63], v[116:119], a[124:127], v[48:63]
    v_fmac_f32 v22, v248, v170
    v_fmac_f32 v23, v248, v171
    ds_read_b128 v[144:147], v229 offset:6144
    s_waitcnt lgkmcnt(5)
    v_mfma_f32_32x32x16_bf16 v[64:79], v[120:123], a[0:3], v[64:79]
    v_fmac_f32 v24, v248, v172
    v_fmac_f32 v25, v248, v173
    ds_read_b128 v[112:115], v229 offset:7168
    v_mfma_f32_32x32x16_bf16 v[64:79], v[124:127], a[4:7], v[64:79]
    s_add_u32 m0, s32, 73728
    s_add_u32 s41, s31, 63488
    buffer_load_dwordx4 v253, s[12:15], s41 offen lds
    v_fmac_f32 v26, v248, v174
    v_fmac_f32 v27, v248, v175
    ds_read_b128 v[116:119], v229 offset:8192
    s_waitcnt lgkmcnt(5)
    v_mfma_f32_32x32x16_bf16 v[64:79], v[128:131], a[8:11], v[64:79]
    v_fmac_f32 v28, v248, v176
    v_fmac_f32 v29, v248, v177
    ds_read_b128 v[120:123], v229 offset:9216
    v_mfma_f32_32x32x16_bf16 v[64:79], v[132:135], a[12:15], v[64:79]
    v_fmac_f32 v30, v248, v178
    v_fmac_f32 v31, v248, v179
    ds_read_b128 v[124:127], v229 offset:10240
    s_waitcnt lgkmcnt(5)
    v_mfma_f32_32x32x16_bf16 v[64:79], v[136:139], a[16:19], v[64:79]
    s_add_u32 m0, s32, 77824
    s_add_u32 s41, s31, 92160
    buffer_load_dwordx4 v253, s[12:15], s41 offen lds
    v_max_f32 v16, 0, v16
    v_max_f32 v17, 0, v17
    ds_read_b128 v[128:131], v229 offset:11264
    v_mfma_f32_32x32x16_bf16 v[64:79], v[140:143], a[20:23], v[64:79]
    v_max_f32 v18, 0, v18
    v_max_f32 v19, 0, v19
    ds_read_b128 v[132:135], v229 offset:12288
    s_waitcnt lgkmcnt(5)
    v_mfma_f32_32x32x16_bf16 v[64:79], v[144:147], a[24:27], v[64:79]
    v_max_f32 v20, 0, v20
    v_max_f32 v21, 0, v21
    ds_read_b128 v[136:139], v229 offset:13312
    v_mfma_f32_32x32x16_bf16 v[64:79], v[112:115], a[28:31], v[64:79]
    s_add_u32 m0, s32, 81920
    s_add_u32 s41, s31, 120832
    buffer_load_dwordx4 v253, s[12:15], s41 offen lds
    v_max_f32 v22, 0, v22
    v_max_f32 v23, 0, v23
    ds_read_b128 v[140:143], v229 offset:14336
    s_waitcnt lgkmcnt(5)
    v_mfma_f32_32x32x16_bf16 v[64:79], v[116:119], a[32:35], v[64:79]
    v_mul_f32 v16, v16, v24
    v_mul_f32 v17, v17, v25
    ds_read_b128 v[144:147], v229 offset:15360
    v_mfma_f32_32x32x16_bf16 v[64:79], v[120:123], a[36:39], v[64:79]
    v_mul_f32 v18, v18, v26
    v_mul_f32 v19, v19, v27
    ds_read_b128 v[112:115], v229 offset:16384
    s_waitcnt lgkmcnt(5)
    v_mfma_f32_32x32x16_bf16 v[64:79], v[124:127], a[40:43], v[64:79]
    s_add_u32 m0, s32, 86016
    s_add_u32 s41, s31, 149504
    buffer_load_dwordx4 v253, s[12:15], s41 offen lds
    v_mul_f32 v20, v20, v28
    v_mul_f32 v21, v21, v29
    ds_read_b128 v[116:119], v229 offset:17408
    v_mfma_f32_32x32x16_bf16 v[64:79], v[128:131], a[44:47], v[64:79]
    v_mul_f32 v22, v22, v30
    v_mul_f32 v23, v23, v31
    ds_read_b128 v[120:123], v229 offset:18432
    s_waitcnt lgkmcnt(5)
    v_mfma_f32_32x32x16_bf16 v[64:79], v[132:135], a[48:51], v[64:79]
    v_cvt_pk_bf16_f32 v24, v16, v17
    v_cvt_pk_bf16_f32 v25, v18, v19
    ds_read_b128 v[124:127], v229 offset:19456
    v_mfma_f32_32x32x16_bf16 v[64:79], v[136:139], a[52:55], v[64:79]
    s_add_u32 m0, s32, 90112
    s_add_u32 s41, s31, 178176
    buffer_load_dwordx4 v253, s[12:15], s41 offen lds
    v_cvt_pk_bf16_f32 v26, v20, v21
    v_cvt_pk_bf16_f32 v27, v22, v23
    ds_read_b128 v[128:131], v229 offset:20480
    s_waitcnt lgkmcnt(5)
    v_mfma_f32_32x32x16_bf16 v[64:79], v[140:143], a[56:59], v[64:79]
    buffer_store_dwordx4 v[24:27], v253, s[12:15], s37 offen offset:1024 sc1
    ds_read_b128 v[132:135], v229 offset:21504
    v_mfma_f32_32x32x16_bf16 v[64:79], v[144:147], a[60:63], v[64:79]
    v_max_f32 v48, 0, v48
    v_max_f32 v49, 0, v49
    ds_read_b128 v[136:139], v229 offset:22528
    s_waitcnt lgkmcnt(5)
    v_mfma_f32_32x32x16_bf16 v[64:79], v[112:115], a[64:67], v[64:79]
    s_add_u32 m0, s32, 94208
    s_add_u32 s41, s31, 206848
    buffer_load_dwordx4 v253, s[12:15], s41 offen lds
    v_max_f32 v50, 0, v50
    v_max_f32 v51, 0, v51
    ds_read_b128 v[140:143], v229 offset:23552
    v_mfma_f32_32x32x16_bf16 v[64:79], v[116:119], a[68:71], v[64:79]
    v_max_f32 v52, 0, v52
    v_max_f32 v53, 0, v53
    ds_read_b128 v[144:147], v229 offset:24576
    ds_read_b128 v[148:151], v237 offset:640
    ds_read_b128 v[152:155], v237 offset:672
    ds_read_b128 v[156:159], v237 offset:704
    ds_read_b128 v[160:163], v237 offset:736
    s_waitcnt lgkmcnt(9)
    v_mfma_f32_32x32x16_bf16 v[64:79], v[120:123], a[72:75], v[64:79]
    v_max_f32 v54, 0, v54
    v_max_f32 v55, 0, v55
    ds_read_b128 v[112:115], v229 offset:25600
    v_mfma_f32_32x32x16_bf16 v[64:79], v[124:127], a[76:79], v[64:79]
    v_mul_f32 v48, v48, v56
    v_mul_f32 v49, v49, v57
    ds_read_b128 v[116:119], v229 offset:26624
    s_waitcnt lgkmcnt(9)
    v_mfma_f32_32x32x16_bf16 v[64:79], v[128:131], a[80:83], v[64:79]
    v_mul_f32 v50, v50, v58
    v_mul_f32 v51, v51, v59
    ds_read_b128 v[120:123], v229 offset:27648
    v_mfma_f32_32x32x16_bf16 v[64:79], v[132:135], a[84:87], v[64:79]
    s_and_b32 s50, s2, 7
    s_lshr_b32 s51, s2, 3
    s_lshl_b32 s50, s50, 2
    s_and_b32 s69, s51, 3
    s_add_u32 s50, s50, s69
    s_lshr_b32 s51, s51, 2
    s_and_b32 s52, s70, 1
    s_lshr_b32 s53, s70, 1
    s_lshl_b32 s54, s50, 1
    s_add_u32 s54, s54, s52
    s_mul_i32 s55, s54, 114688
    s_lshl_b32 s69, s53, 11
    s_add_u32 s55, s55, s69
    s_add_u32 s55, s55, 16777216
    s_lshl_b32 s65, s52, 12
    s_add_u32 s65, s65, s69
    s_mul_i32 s64, s51, 229376
    s_lshl_b32 s68, s70, 11
    s_add_u32 s64, s64, s68
    s_add_u32 s64, s64, 33554432
    v_mul_f32 v52, v52, v60
    v_mul_f32 v53, v53, v61
    ds_read_b128 v[124:127], v229 offset:28672
    s_waitcnt lgkmcnt(9)
    v_mfma_f32_32x32x16_bf16 v[64:79], v[136:139], a[88:91], v[64:79]
    s_add_u32 m0, s68, 131072
    s_nop 0
    buffer_load_dwordx4 v253, s[12:15], s64 offen lds
    buffer_load_dwordx4 v253, s[12:15], s64 offen offset:1024 lds
    s_add_u32 s64, s64, 8192
    v_mul_f32 v54, v54, v62
    v_mul_f32 v55, v55, v63
    ds_read_b128 v[128:131], v229 offset:29696
    v_mfma_f32_32x32x16_bf16 v[64:79], v[140:143], a[92:95], v[64:79]
    s_waitcnt lgkmcnt(5)
    v_mul_f32 v80, v248, v148
    v_mul_f32 v81, v248, v149
    v_mul_f32 v82, v248, v150
    ds_read_b128 v[132:135], v229 offset:30720
    s_waitcnt lgkmcnt(5)
    v_mfma_f32_32x32x16_bf16 v[64:79], v[144:147], a[96:99], v[64:79]
    v_mul_f32 v83, v248, v151
    v_mul_f32 v84, v248, v152
    v_mul_f32 v85, v248, v153
    ds_read_b128 v[136:139], v229 offset:31744
    v_mfma_f32_32x32x16_bf16 v[64:79], v[112:115], a[100:103], v[64:79]
    s_add_u32 m0, s68, 139264
    s_nop 0
    buffer_load_dwordx4 v253, s[12:15], s64 offen lds
    buffer_load_dwordx4 v253, s[12:15], s64 offen offset:1024 lds
    s_add_u32 s64, s64, 8192
    v_mul_f32 v86, v248, v154
    v_mul_f32 v87, v248, v155
    v_mul_f32 v88, v248, v156
    s_waitcnt vmcnt(14)
    s_barrier
    ds_read_b128 v[140:143], v229 offset:32768
    s_waitcnt lgkmcnt(5)
    v_mfma_f32_32x32x16_bf16 v[64:79], v[116:119], a[104:107], v[64:79]
    v_mul_f32 v89, v248, v157
    v_mul_f32 v90, v248, v158
    v_mul_f32 v91, v248, v159
    ds_read_b128 v[144:147], v229 offset:33792
    v_mfma_f32_32x32x16_bf16 v[64:79], v[120:123], a[108:111], v[64:79]
    v_mul_f32 v92, v248, v160
    v_mul_f32 v93, v248, v161
    v_mul_f32 v94, v248, v162
    ds_read_b128 v[112:115], v229 offset:34816
    ds_read_b128 v[164:167], v237 offset:256
    ds_read_b128 v[168:171], v237 offset:288
    ds_read_b128 v[172:175], v237 offset:320
    ds_read_b128 v[176:179], v237 offset:352
    s_waitcnt lgkmcnt(9)
    v_mfma_f32_32x32x16_bf16 v[64:79], v[124:127], a[112:115], v[64:79]
    s_add_u32 m0, s68, 147456
    s_nop 0
    buffer_load_dwordx4 v253, s[12:15], s64 offen lds
    buffer_load_dwordx4 v253, s[12:15], s64 offen offset:1024 lds
    s_add_u32 s64, s64, 8192
    v_mul_f32 v95, v248, v163
    ds_read_b128 v[116:119], v229 offset:35840
    v_mfma_f32_32x32x16_bf16 v[64:79], v[128:131], a[116:119], v[64:79]
    v_cvt_pk_bf16_f32 v56, v48, v49
    v_cvt_pk_bf16_f32 v57, v50, v51
    ds_read_b128 v[120:123], v229 offset:36864
    s_waitcnt lgkmcnt(9)
    v_mfma_f32_32x32x16_bf16 v[64:79], v[132:135], a[120:123], v[64:79]
    v_cvt_pk_bf16_f32 v58, v52, v53
    v_cvt_pk_bf16_f32 v59, v54, v55
    ds_read_b128 v[124:127], v229 offset:37888
    v_mfma_f32_32x32x16_bf16 v[64:79], v[136:139], a[124:127], v[64:79]
    buffer_store_dwordx4 v[56:59], v253, s[12:15], s37 offen offset:3072 sc1
    ds_read_b128 v[128:131], v229 offset:38912
    s_waitcnt lgkmcnt(9)
    v_mfma_f32_32x32x16_bf16 v[80:95], v[140:143], a[0:3], v[80:95]
    s_add_u32 m0, s68, 98304
    s_nop 0
    buffer_load_dwordx4 v253, s[12:15], s64 offen lds
    buffer_load_dwordx4 v253, s[12:15], s64 offen offset:1024 lds
    s_add_u32 s64, s64, 8192
    s_waitcnt lgkmcnt(4)
    v_fmac_f32 v32, v248, v164
    v_fmac_f32 v33, v248, v165
    ds_read_b128 v[132:135], v229 offset:39936
    v_mfma_f32_32x32x16_bf16 v[80:95], v[144:147], a[4:7], v[80:95]
    v_fmac_f32 v34, v248, v166
    v_fmac_f32 v35, v248, v167
    ds_read_b128 v[136:139], v229 offset:40960
    s_waitcnt lgkmcnt(5)
    v_mfma_f32_32x32x16_bf16 v[80:95], v[112:115], a[8:11], v[80:95]
    v_fmac_f32 v36, v248, v168
    v_fmac_f32 v37, v248, v169
    ds_read_b128 v[140:143], v229 offset:41984
    v_mfma_f32_32x32x16_bf16 v[80:95], v[116:119], a[12:15], v[80:95]
    v_fmac_f32 v38, v248, v170
    v_fmac_f32 v39, v248, v171
    ds_read_b128 v[144:147], v229 offset:43008
    s_waitcnt lgkmcnt(5)
    v_mfma_f32_32x32x16_bf16 v[80:95], v[120:123], a[16:19], v[80:95]
    s_add_u32 m0, s68, 106496
    s_nop 0
    buffer_load_dwordx4 v253, s[12:15], s64 offen lds
    buffer_load_dwordx4 v253, s[12:15], s64 offen offset:1024 lds
    s_add_u32 s64, s64, 8192
    v_fmac_f32 v40, v248, v172
    v_fmac_f32 v41, v248, v173
    ds_read_b128 v[112:115], v229 offset:44032
    v_mfma_f32_32x32x16_bf16 v[80:95], v[124:127], a[20:23], v[80:95]
    v_fmac_f32 v42, v248, v174
    v_fmac_f32 v43, v248, v175
    ds_read_b128 v[116:119], v229 offset:45056
    s_waitcnt lgkmcnt(5)
    v_mfma_f32_32x32x16_bf16 v[80:95], v[128:131], a[24:27], v[80:95]
    v_fmac_f32 v44, v248, v176
    v_fmac_f32 v45, v248, v177
    ds_read_b128 v[120:123], v229 offset:46080
    v_mfma_f32_32x32x16_bf16 v[80:95], v[132:135], a[28:31], v[80:95]
    v_fmac_f32 v46, v248, v178
    v_fmac_f32 v47, v248, v179
    ds_read_b128 v[124:127], v229 offset:47104
    s_waitcnt lgkmcnt(5)
    v_mfma_f32_32x32x16_bf16 v[80:95], v[136:139], a[32:35], v[80:95]
    s_add_u32 m0, s68, 114688
    s_nop 0
    buffer_load_dwordx4 v253, s[12:15], s64 offen lds
    buffer_load_dwordx4 v253, s[12:15], s64 offen offset:1024 lds
    s_add_u32 s64, s64, 8192
    v_max_f32 v32, 0, v32
    v_max_f32 v33, 0, v33
    ds_read_b128 v[128:131], v229 offset:48128
    v_mfma_f32_32x32x16_bf16 v[80:95], v[140:143], a[36:39], v[80:95]
    v_max_f32 v34, 0, v34
    v_max_f32 v35, 0, v35
    ds_read_b128 v[132:135], v230 offset:0
    s_waitcnt lgkmcnt(5)
    v_mfma_f32_32x32x16_bf16 v[80:95], v[144:147], a[40:43], v[80:95]
    v_max_f32 v36, 0, v36
    v_max_f32 v37, 0, v37
    ds_read_b128 v[136:139], v230 offset:1024
    v_mfma_f32_32x32x16_bf16 v[80:95], v[112:115], a[44:47], v[80:95]
    v_max_f32 v38, 0, v38
    v_max_f32 v39, 0, v39
    ds_read_b128 v[140:143], v230 offset:2048
    s_waitcnt lgkmcnt(5)
    v_mfma_f32_32x32x16_bf16 v[80:95], v[116:119], a[48:51], v[80:95]
    s_add_u32 m0, s68, 122880
    s_nop 0
    buffer_load_dwordx4 v253, s[12:15], s64 offen lds
    buffer_load_dwordx4 v253, s[12:15], s64 offen offset:1024 lds
    s_add_u32 s64, s64, 8192
    v_mul_f32 v32, v32, v40
    v_mul_f32 v33, v33, v41
    ds_read_b128 v[144:147], v230 offset:3072
    v_mfma_f32_32x32x16_bf16 v[80:95], v[120:123], a[52:55], v[80:95]
    v_mul_f32 v34, v34, v42
    v_mul_f32 v35, v35, v43
    ds_read_b128 v[112:115], v230 offset:4096
    s_waitcnt lgkmcnt(5)
    v_mfma_f32_32x32x16_bf16 v[80:95], v[124:127], a[56:59], v[80:95]
    v_mul_f32 v36, v36, v44
    v_mul_f32 v37, v37, v45
    ds_read_b128 v[116:119], v230 offset:5120
    v_mfma_f32_32x32x16_bf16 v[80:95], v[128:131], a[60:63], v[80:95]
    v_mul_f32 v38, v38, v46
    v_mul_f32 v39, v39, v47
    ds_read_b128 v[120:123], v230 offset:6144
    s_waitcnt lgkmcnt(5)
    v_mfma_f32_32x32x16_bf16 v[80:95], v[132:135], a[64:67], v[80:95]
    v_cvt_pk_bf16_f32 v40, v32, v33
    v_cvt_pk_bf16_f32 v41, v34, v35
    ds_read_b128 v[124:127], v230 offset:7168
    v_mfma_f32_32x32x16_bf16 v[80:95], v[136:139], a[68:71], v[80:95]
    v_cvt_pk_bf16_f32 v42, v36, v37
    v_cvt_pk_bf16_f32 v43, v38, v39
    ds_read_b128 v[128:131], v230 offset:8192
    ds_read_b128 v[148:151], v237 offset:768
    ds_read_b128 v[152:155], v237 offset:800
    ds_read_b128 v[156:159], v237 offset:832
    ds_read_b128 v[160:163], v237 offset:864
    s_waitcnt lgkmcnt(9)
    v_mfma_f32_32x32x16_bf16 v[80:95], v[140:143], a[72:75], v[80:95]
    buffer_store_dwordx4 v[40:43], v253, s[12:15], s37 offen offset:2048 sc1
    ds_read_b128 v[132:135], v230 offset:9216
    v_mfma_f32_32x32x16_bf16 v[80:95], v[144:147], a[76:79], v[80:95]
    v_max_f32 v64, 0, v64
    v_max_f32 v65, 0, v65
    ds_read_b128 v[136:139], v230 offset:10240
    s_waitcnt lgkmcnt(9)
    v_mfma_f32_32x32x16_bf16 v[80:95], v[112:115], a[80:83], v[80:95]
    v_max_f32 v66, 0, v66
    v_max_f32 v67, 0, v67
    ds_read_b128 v[140:143], v230 offset:11264
    v_mfma_f32_32x32x16_bf16 v[80:95], v[116:119], a[84:87], v[80:95]
    v_max_f32 v68, 0, v68
    v_max_f32 v69, 0, v69
    ds_read_b128 v[144:147], v230 offset:12288
    s_waitcnt lgkmcnt(9)
    v_mfma_f32_32x32x16_bf16 v[80:95], v[120:123], a[88:91], v[80:95]
    v_max_f32 v70, 0, v70
    v_max_f32 v71, 0, v71
    ds_read_b128 v[112:115], v230 offset:13312
    v_mfma_f32_32x32x16_bf16 v[80:95], v[124:127], a[92:95], v[80:95]
    s_waitcnt lgkmcnt(5)
    v_mul_f32 v96, v248, v148
    v_mul_f32 v97, v248, v149
    v_mul_f32 v98, v248, v150
    ds_read_b128 v[116:119], v230 offset:14336
    s_waitcnt lgkmcnt(5)
    v_mfma_f32_32x32x16_bf16 v[80:95], v[128:131], a[96:99], v[80:95]
    v_mul_f32 v99, v248, v151
    v_mul_f32 v100, v248, v152
    v_mul_f32 v101, v248, v153
    ds_read_b128 v[120:123], v230 offset:15360
    v_mfma_f32_32x32x16_bf16 v[80:95], v[132:135], a[100:103], v[80:95]
    v_mul_f32 v102, v248, v154
    v_mul_f32 v103, v248, v155
    v_mul_f32 v104, v248, v156
    s_waitcnt vmcnt(0)
    s_barrier
    s_cmp_lg_u32 s70, 0
    s_cbranch_scc1 blk1_kernel_es_4
    v_mov_b32 v254, 0
    v_mov_b32 v255, 1
    s_and_b32 s43, s72, 0xffffff80
    s_add_u32 s43, s43, 8192
    s_mov_b64 exec, 1
    buffer_atomic_add v255, v254, s[12:15], s43 offen sc1
    s_mov_b64 exec, -1
blk1_kernel_es_4:
    ds_read_b128 v[124:127], v230 offset:16384
    s_waitcnt lgkmcnt(5)
    v_mfma_f32_32x32x16_bf16 v[80:95], v[136:139], a[104:107], v[80:95]
    v_mul_f32 v105, v248, v157
    v_mul_f32 v106, v248, v158
    v_mul_f32 v107, v248, v159
    ds_read_b128 v[128:131], v230 offset:17408
    v_mfma_f32_32x32x16_bf16 v[80:95], v[140:143], a[108:111], v[80:95]
    v_mul_f32 v108, v248, v160
    v_mul_f32 v109, v248, v161
    v_mul_f32 v110, v248, v162
    ds_read_b128 v[132:135], v230 offset:18432
    s_waitcnt lgkmcnt(5)
    v_mfma_f32_32x32x16_bf16 v[80:95], v[144:147], a[112:115], v[80:95]
    s_add_u32 m0, s68, 0
    s_nop 0
    buffer_load_dwordx4 v253, s[12:15], s64 offen lds
    buffer_load_dwordx4 v253, s[12:15], s64 offen offset:1024 lds
    s_add_u32 s64, s64, 8192
    v_mul_f32 v111, v248, v163
    ds_read_b128 v[136:139], v230 offset:19456
    v_mfma_f32_32x32x16_bf16 v[80:95], v[112:115], a[116:119], v[80:95]
    v_mul_f32 v64, v64, v72
    v_mul_f32 v65, v65, v73
    ds_read_b128 v[140:143], v230 offset:20480
    s_waitcnt lgkmcnt(5)
    v_mfma_f32_32x32x16_bf16 v[80:95], v[116:119], a[120:123], v[80:95]
    v_mul_f32 v66, v66, v74
    v_mul_f32 v67, v67, v75
    ds_read_b128 v[144:147], v230 offset:21504
    v_mfma_f32_32x32x16_bf16 v[80:95], v[120:123], a[124:127], v[80:95]
    v_mul_f32 v68, v68, v76
    v_mul_f32 v69, v69, v77
    ds_read_b128 v[112:115], v230 offset:22528
    s_waitcnt lgkmcnt(5)
    v_mfma_f32_32x32x16_bf16 v[96:111], v[124:127], a[0:3], v[96:111]
    s_add_u32 m0, s68, 8192
    s_nop 0
    buffer_load_dwordx4 v253, s[12:15], s64 offen lds
    buffer_load_dwordx4 v253, s[12:15], s64 offen offset:1024 lds
    s_add_u32 s64, s64, 8192
    v_mul_f32 v70, v70, v78
    v_mul_f32 v71, v71, v79
    ds_read_b128 v[116:119], v230 offset:23552
    v_mfma_f32_32x32x16_bf16 v[96:111], v[128:131], a[4:7], v[96:111]
    v_cvt_pk_bf16_f32 v72, v64, v65
    v_cvt_pk_bf16_f32 v73, v66, v67
    ds_read_b128 v[120:123], v230 offset:24576
    s_waitcnt lgkmcnt(5)
    v_mfma_f32_32x32x16_bf16 v[96:111], v[132:135], a[8:11], v[96:111]
    v_cvt_pk_bf16_f32 v74, v68, v69
    v_cvt_pk_bf16_f32 v75, v70, v71
    ds_read_b128 v[124:127], v230 offset:25600
    v_mfma_f32_32x32x16_bf16 v[96:111], v[136:139], a[12:15], v[96:111]
    buffer_store_dwordx4 v[72:75], v253, s[12:15], s38 offen offset:0 sc1
    ds_read_b128 v[128:131], v230 offset:26624
    s_waitcnt lgkmcnt(5)
    v_mfma_f32_32x32x16_bf16 v[96:111], v[140:143], a[16:19], v[96:111]
    s_add_u32 m0, s68, 16384
    s_nop 0
    buffer_load_dwordx4 v253, s[12:15], s64 offen lds
    buffer_load_dwordx4 v253, s[12:15], s64 offen offset:1024 lds
    s_add_u32 s64, s64, 8192
    v_max_f32 v80, 0, v80
    v_max_f32 v81, 0, v81
    ds_read_b128 v[132:135], v230 offset:27648
    v_mfma_f32_32x32x16_bf16 v[96:111], v[144:147], a[20:23], v[96:111]
    v_max_f32 v82, 0, v82
    v_max_f32 v83, 0, v83
    ds_read_b128 v[136:139], v230 offset:28672
    s_waitcnt lgkmcnt(5)
    v_mfma_f32_32x32x16_bf16 v[96:111], v[112:115], a[24:27], v[96:111]
    v_max_f32 v84, 0, v84
    v_max_f32 v85, 0, v85
    ds_read_b128 v[140:143], v230 offset:29696
    v_mfma_f32_32x32x16_bf16 v[96:111], v[116:119], a[28:31], v[96:111]
    v_max_f32 v86, 0, v86
    v_max_f32 v87, 0, v87
    ds_read_b128 v[144:147], v230 offset:30720
    s_waitcnt lgkmcnt(5)
    v_mfma_f32_32x32x16_bf16 v[96:111], v[120:123], a[32:35], v[96:111]
    s_add_u32 m0, s68, 24576
    s_nop 0
    buffer_load_dwordx4 v253, s[12:15], s64 offen lds
    buffer_load_dwordx4 v253, s[12:15], s64 offen offset:1024 lds
    s_add_u32 s64, s64, 8192
    v_mul_f32 v80, v80, v88
    v_mul_f32 v81, v81, v89
    ds_read_b128 v[112:115], v230 offset:31744
    v_mfma_f32_32x32x16_bf16 v[96:111], v[124:127], a[36:39], v[96:111]
    v_mul_f32 v82, v82, v90
    v_mul_f32 v83, v83, v91
    ds_read_b128 v[116:119], v230 offset:32768
    s_waitcnt lgkmcnt(5)
    v_mfma_f32_32x32x16_bf16 v[96:111], v[128:131], a[40:43], v[96:111]
    v_mul_f32 v84, v84, v92
    v_mul_f32 v85, v85, v93
    ds_read_b128 v[120:123], v230 offset:33792
    v_mfma_f32_32x32x16_bf16 v[96:111], v[132:135], a[44:47], v[96:111]
    v_mul_f32 v86, v86, v94
    v_mul_f32 v87, v87, v95
    ds_read_b128 v[124:127], v230 offset:34816
    s_waitcnt lgkmcnt(5)
    v_mfma_f32_32x32x16_bf16 v[96:111], v[136:139], a[48:51], v[96:111]
    v_cvt_pk_bf16_f32 v88, v80, v81
    v_cvt_pk_bf16_f32 v89, v82, v83
    ds_read_b128 v[128:131], v230 offset:35840
    v_mfma_f32_32x32x16_bf16 v[96:111], v[140:143], a[52:55], v[96:111]
    v_cvt_pk_bf16_f32 v90, v84, v85
    v_cvt_pk_bf16_f32 v91, v86, v87
    ds_read_b128 v[132:135], v230 offset:36864
    s_waitcnt lgkmcnt(5)
    v_mfma_f32_32x32x16_bf16 v[96:111], v[144:147], a[56:59], v[96:111]
    buffer_store_dwordx4 v[88:91], v253, s[12:15], s38 offen offset:1024 sc1
    ds_read_b128 v[136:139], v230 offset:37888
    v_mfma_f32_32x32x16_bf16 v[96:111], v[112:115], a[60:63], v[96:111]
    ds_read_b128 v[140:143], v230 offset:38912
    s_waitcnt lgkmcnt(5)
    v_mfma_f32_32x32x16_bf16 v[96:111], v[116:119], a[64:67], v[96:111]
    ds_read_b128 v[144:147], v230 offset:39936
    v_mfma_f32_32x32x16_bf16 v[96:111], v[120:123], a[68:71], v[96:111]
    ds_read_b128 v[112:115], v230 offset:40960
    s_waitcnt lgkmcnt(5)
    v_mfma_f32_32x32x16_bf16 v[96:111], v[124:127], a[72:75], v[96:111]
    ds_read_b128 v[116:119], v230 offset:41984
    v_mfma_f32_32x32x16_bf16 v[96:111], v[128:131], a[76:79], v[96:111]
    ds_read_b128 v[120:123], v230 offset:43008
    s_waitcnt lgkmcnt(5)
    v_mfma_f32_32x32x16_bf16 v[96:111], v[132:135], a[80:83], v[96:111]
    ds_read_b128 v[124:127], v230 offset:44032
    v_mfma_f32_32x32x16_bf16 v[96:111], v[136:139], a[84:87], v[96:111]
    ds_read_b128 v[128:131], v230 offset:45056
    s_waitcnt lgkmcnt(5)
    v_mfma_f32_32x32x16_bf16 v[96:111], v[140:143], a[88:91], v[96:111]
    ds_read_b128 v[132:135], v230 offset:46080
    v_mfma_f32_32x32x16_bf16 v[96:111], v[144:147], a[92:95], v[96:111]
    ds_read_b128 v[136:139], v230 offset:47104
    s_waitcnt lgkmcnt(5)
    v_mfma_f32_32x32x16_bf16 v[96:111], v[112:115], a[96:99], v[96:111]
    ds_read_b128 v[140:143], v230 offset:48128
    v_mfma_f32_32x32x16_bf16 v[96:111], v[116:119], a[100:103], v[96:111]
    s_nop 0
    s_waitcnt lgkmcnt(4)
    v_mfma_f32_32x32x16_bf16 v[96:111], v[120:123], a[104:107], v[96:111]
    s_nop 0
    v_mfma_f32_32x32x16_bf16 v[96:111], v[124:127], a[108:111], v[96:111]
    s_nop 0
    s_waitcnt lgkmcnt(2)
    v_mfma_f32_32x32x16_bf16 v[96:111], v[128:131], a[112:115], v[96:111]
    s_nop 0
    v_mfma_f32_32x32x16_bf16 v[96:111], v[132:135], a[116:119], v[96:111]
    s_nop 0
    s_waitcnt lgkmcnt(0)
    v_mfma_f32_32x32x16_bf16 v[96:111], v[136:139], a[120:123], v[96:111]
    s_nop 0
    v_mfma_f32_32x32x16_bf16 v[96:111], v[140:143], a[124:127], v[96:111]
    s_nop 0
    s_lshr_b32 s73, s50, 1
    s_lshl_b32 s73, s73, 7
    s_add_u32 s73, s73, 36712448
    s_nop 7
    v_max_f32 v96, 0, v96
    s_nop 5
    v_max_f32 v97, 0, v97
    s_nop 3
    v_max_f32 v98, 0, v98
    s_nop 1
    v_max_f32 v99, 0, v99
    v_max_f32 v100, 0, v100
    v_max_f32 v101, 0, v101
    v_max_f32 v102, 0, v102
    v_max_f32 v103, 0, v103
    v_mul_f32 v96, v96, v104
    v_mul_f32 v97, v97, v105
    v_mul_f32 v98, v98, v106
    v_mul_f32 v99, v99, v107
    v_mul_f32 v100, v100, v108
    v_mul_f32 v101, v101, v109
    v_mul_f32 v102, v102, v110
    v_mul_f32 v103, v103, v111
    v_cvt_pk_bf16_f32 v104, v96, v97
    v_cvt_pk_bf16_f32 v105, v98, v99
    v_cvt_pk_bf16_f32 v106, v100, v101
    v_cvt_pk_bf16_f32 v107, v102, v103
    buffer_store_dwordx4 v[104:107], v253, s[12:15], s38 offen offset:2048 sc1
    s_cmp_lg_u32 s70, 0
    s_cbranch_scc1 blk1_kernel_pok_6
    s_add_u32 s66, s8, s73
    s_addc_u32 s67, s9, 0
    s_mov_b32 s74, 0
blk1_kernel_poll_5:
    s_load_dword s16, s[66:67], 0 glc
    s_add_u32 s74, s74, 1
    s_waitcnt lgkmcnt(0)
    s_cmp_eq_u32 s16, 16
    s_cbranch_scc1 blk1_kernel_pok_6
    s_sleep 2
    s_cmp_lt_u32 s74, 0x40000
    s_cbranch_scc1 blk1_kernel_poll_5
blk1_kernel_pok_6:
    s_barrier
    s_sub_u32 s73, s73, 8192
    s_add_u32 m0, s65, 57344
    s_nop 0
    buffer_load_dwordx4 v253, s[12:15], s55 offen sc1 lds
    buffer_load_dwordx4 v253, s[12:15], s55 offen offset:1024 sc1 lds
    s_add_u32 s55, s55, 4096
    s_add_u32 m0, s65, 65536
    s_nop 0
    buffer_load_dwordx4 v253, s[12:15], s55 offen sc1 lds
    buffer_load_dwordx4 v253, s[12:15], s55 offen offset:1024 sc1 lds
    s_add_u32 s55, s55, 4096
    s_add_u32 m0, s65, 73728
    s_nop 0
    buffer_load_dwordx4 v253, s[12:15], s55 offen sc1 lds
    buffer_load_dwordx4 v253, s[12:15], s55 offen offset:1024 sc1 lds
    s_add_u32 s55, s55, 4096
    s_add_u32 m0, s65, 81920
    s_nop 0
    buffer_load_dwordx4 v253, s[12:15], s55 offen sc1 lds
    buffer_load_dwordx4 v253, s[12:15], s55 offen offset:1024 sc1 lds
    s_add_u32 s55, s55, 4096
    s_add_u32 m0, s65, 90112
    s_nop 0
    buffer_load_dwordx4 v253, s[12:15], s55 offen sc1 lds
    buffer_load_dwordx4 v253, s[12:15], s55 offen offset:1024 sc1 lds
    s_add_u32 s55, s55, 4096
    s_lshl_b32 s56, s54, 15
    s_lshl_b32 s57, s51, 12
    s_lshl_b32 s58, s53, 11
    s_add_u32 s57, s57, s58
    s_add_u32 s57, s57, s56
    s_add_u32 s58, s57, 10485760
    buffer_load_dwordx4 v[48:51], v253, s[12:15], s58 offen sc1
    buffer_load_dwordx4 v[52:55], v253, s[12:15], s58 offen offset:1024 sc1
    v_and_b32 v72, 31, v252
    v_lshlrev_b32 v72, 2, v72
    s_lshl_b32 s58, s54, 7
    s_add_u32 s58, s58, 7864320
    buffer_load_dword v73, v72, s[12:15], s58 offen sc1
    s_lshl_b32 s59, s52, 12
    v_add_u32 v56, s59, v253
    v_add_u32 v57, 57344, v56
    v_add_u32 v58, 114688, v56
    s_lshl_b32 s59, s53, 10
    v_add_u32 v59, s59, v253
    v_add_u32 v60, 57344, v59
    v_add_u32 v61, 114688, v59
    s_waitcnt vmcnt(11)
    s_barrier
    s_cmp_lg_u32 s70, 0
    s_cbranch_scc1 blk1_kernel_sig_7
    v_mov_b32 v254, 0
    v_mov_b32 v255, 1
    s_mov_b64 exec, 1
    s_and_b32 s72, s72, 0xffffff80
    buffer_atomic_add v255, v254, s[12:15], s72 offen sc1
    s_mov_b64 exec, -1
blk1_kernel_sig_7:
    ds_read_b128 v[96:99], v57 offset:0
    ds_read_b128 v[112:115], v61 offset:16384
    s_add_u32 m0, s65, 32768
    s_nop 0
    buffer_load_dwordx4 v253, s[12:15], s55 offen sc1 lds
    ds_read_b128 v[100:103], v57 offset:1024
    ds_read_b128 v[116:119], v61 offset:18432
    buffer_load_dwordx4 v253, s[12:15], s55 offen offset:1024 sc1 lds
    s_add_u32 s55, s55, 4096
    ds_read_b128 v[104:107], v57 offset:2048
    ds_read_b128 v[120:123], v61 offset:20480
    ds_read_b128 v[108:111], v57 offset:3072
    ds_read_b128 v[124:127], v61 offset:22528
    s_waitcnt vmcnt(11)
    s_barrier
    s_waitcnt lgkmcnt(6)
    v_mfma_f32_32x32x16_bf16 v[0:15], v[112:115], v[96:99], 0
    ds_read_b128 v[128:131], v57 offset:8192
    ds_read_b128 v[144:147], v61 offset:24576
    s_add_u32 m0, s65, 40960
    s_nop 0
    buffer_load_dwordx4 v253, s[12:15], s55 offen sc1 lds
    s_waitcnt lgkmcnt(6)
    v_mfma_f32_32x32x16_bf16 v[0:15], v[116:119], v[100:103], v[0:15]
    ds_read_b128 v[132:135], v57 offset:9216
    ds_read_b128 v[148:151], v61 offset:26624
    buffer_load_dwordx4 v253, s[12:15], s55 offen offset:1024 sc1 lds
    s_add_u32 s55, s55, 4096
    s_waitcnt lgkmcnt(6)
    v_mfma_f32_32x32x16_bf16 v[0:15], v[120:123], v[104:107], v[0:15]
    ds_read_b128 v[136:139], v57 offset:10240
    ds_read_b128 v[152:155], v61 offset:28672
    s_waitcnt lgkmcnt(6)
    v_mfma_f32_32x32x16_bf16 v[0:15], v[124:127], v[108:111], v[0:15]
    ds_read_b128 v[140:143], v57 offset:11264
    ds_read_b128 v[156:159], v61 offset:30720
    s_waitcnt vmcnt(11)
    s_barrier
    s_waitcnt lgkmcnt(6)
    v_mfma_f32_32x32x16_bf16 v[0:15], v[144:147], v[128:131], v[0:15]
    ds_read_b128 v[96:99], v57 offset:16384
    ds_read_b128 v[112:115], v61 offset:32768
    s_add_u32 m0, s65, 49152
    s_nop 0
    buffer_load_dwordx4 v253, s[12:15], s55 offen sc1 lds
    s_waitcnt lgkmcnt(6)
    v_mfma_f32_32x32x16_bf16 v[0:15], v[148:151], v[132:135], v[0:15]
    ds_read_b128 v[100:103], v57 offset:17408
    ds_read_b128 v[116:119], v61 offset:34816
    buffer_load_dwordx4 v253, s[12:15], s55 offen offset:1024 sc1 lds
    s_add_u32 s55, s55, 4096
    s_waitcnt lgkmcnt(6)
    v_mfma_f32_32x32x16_bf16 v[0:15], v[152:155], v[136:139], v[0:15]
    ds_read_b128 v[104:107], v57 offset:18432
    ds_read_b128 v[120:123], v61 offset:36864
    s_waitcnt lgkmcnt(6)
    v_mfma_f32_32x32x16_bf16 v[0:15], v[156:159], v[140:143], v[0:15]
    ds_read_b128 v[108:111], v57 offset:19456
    ds_read_b128 v[124:127], v61 offset:38912
    s_waitcnt vmcnt(11)
    s_barrier
    s_waitcnt lgkmcnt(6)
    v_mfma_f32_32x32x16_bf16 v[0:15], v[112:115], v[96:99], v[0:15]
    ds_read_b128 v[128:131], v57 offset:24576
    ds_read_b128 v[144:147], v60 offset:40960
    s_add_u32 m0, s65, 57344
    s_nop 0
    buffer_load_dwordx4 v253, s[12:15], s55 offen sc1 lds
    s_waitcnt lgkmcnt(6)
    v_mfma_f32_32x32x16_bf16 v[0:15], v[116:119], v[100:103], v[0:15]
    ds_read_b128 v[132:135], v57 offset:25600
    ds_read_b128 v[148:151], v60 offset:43008
    buffer_load_dwordx4 v253, s[12:15], s55 offen offset:1024 sc1 lds
    s_add_u32 s55, s55, 4096
    s_waitcnt lgkmcnt(6)
    v_mfma_f32_32x32x16_bf16 v[0:15], v[120:123], v[104:107], v[0:15]
    ds_read_b128 v[136:139], v57 offset:26624
    ds_read_b128 v[152:155], v60 offset:45056
    s_waitcnt lgkmcnt(6)
    v_mfma_f32_32x32x16_bf16 v[0:15], v[124:127], v[108:111], v[0:15]
    ds_read_b128 v[140:143], v57 offset:27648
    ds_read_b128 v[156:159], v60 offset:47104
    s_waitcnt vmcnt(11)
    s_barrier
    s_waitcnt lgkmcnt(6)
    v_mfma_f32_32x32x16_bf16 v[0:15], v[144:147], v[128:131], v[0:15]
    ds_read_b128 v[96:99], v57 offset:32768
    ds_read_b128 v[112:115], v60 offset:49152
    s_add_u32 m0, s65, 131072
    s_nop 0
    buffer_load_dwordx4 v253, s[12:15], s55 offen sc1 lds
    s_waitcnt lgkmcnt(6)
    v_mfma_f32_32x32x16_bf16 v[0:15], v[148:151], v[132:135], v[0:15]
    ds_read_b128 v[100:103], v57 offset:33792
    ds_read_b128 v[116:119], v60 offset:51200
    buffer_load_dwordx4 v253, s[12:15], s55 offen offset:1024 sc1 lds
    s_add_u32 s55, s55, 4096
    s_waitcnt lgkmcnt(6)
    v_mfma_f32_32x32x16_bf16 v[0:15], v[152:155], v[136:139], v[0:15]
    ds_read_b128 v[104:107], v57 offset:34816
    ds_read_b128 v[120:123], v60 offset:53248
    s_add_u32 m0, s68, 65536
    s_nop 0
    buffer_load_dwordx4 v253, s[12:15], s64 offen lds
    s_waitcnt lgkmcnt(6)
    v_mfma_f32_32x32x16_bf16 v[0:15], v[156:159], v[140:143], v[0:15]
    ds_read_b128 v[108:111], v57 offset:35840
    ds_read_b128 v[124:127], v60 offset:55296
    buffer_load_dwordx4 v253, s[12:15], s64 offen offset:1024 lds
    s_add_u32 s64, s64, 8192
    s_waitcnt vmcnt(10)
    s_barrier
    s_waitcnt lgkmcnt(6)
    v_mfma_f32_32x32x16_bf16 v[0:15], v[112:115], v[96:99], v[0:15]
    ds_read_b128 v[128:131], v56 offset:32768
    ds_read_b128 v[144:147], v61 offset:0
    s_add_u32 m0, s65, 139264
    s_nop 0
    buffer_load_dwordx4 v253, s[12:15], s55 offen sc1 lds
    s_waitcnt lgkmcnt(6)
    v_mfma_f32_32x32x16_bf16 v[0:15], v[116:119], v[100:103], v[0:15]
    ds_read_b128 v[132:135], v56 offset:33792
    ds_read_b128 v[148:151], v61 offset:2048
    buffer_load_dwordx4 v253, s[12:15], s55 offen offset:1024 sc1 lds
    s_add_u32 s55, s55, 4096
    s_waitcnt lgkmcnt(6)
    v_mfma_f32_32x32x16_bf16 v[0:15], v[120:123], v[104:107], v[0:15]
    ds_read_b128 v[136:139], v56 offset:34816
    ds_read_b128 v[152:155], v61 offset:4096
    s_add_u32 m0, s68, 73728
    s_nop 0
    buffer_load_dwordx4 v253, s[12:15], s64 offen lds
    s_waitcnt lgkmcnt(6)
    v_mfma_f32_32x32x16_bf16 v[0:15], v[124:127], v[108:111], v[0:15]
    ds_read_b128 v[140:143], v56 offset:35840
    ds_read_b128 v[156:159], v61 offset:6144
    buffer_load_dwordx4 v253, s[12:15], s64 offen offset:1024 lds
    s_add_u32 s64, s64, 8192
    s_waitcnt vmcnt(12)
    s_barrier
    s_waitcnt lgkmcnt(6)
    v_mfma_f32_32x32x16_bf16 v[0:15], v[144:147], v[128:131], v[0:15]
    ds_read_b128 v[96:99], v56 offset:40960
    ds_read_b128 v[112:115], v61 offset:8192
    s_add_u32 m0, s65, 147456
    s_nop 0
    buffer_load_dwordx4 v253, s[12:15], s55 offen sc1 lds
    s_waitcnt lgkmcnt(6)
    v_mfma_f32_32x32x16_bf16 v[0:15], v[148:151], v[132:135], v[0:15]
    ds_read_b128 v[100:103], v56 offset:41984
    ds_read_b128 v[116:119], v61 offset:10240
    buffer_load_dwordx4 v253, s[12:15], s55 offen offset:1024 sc1 lds
    s_add_u32 s55, s55, 4096
    s_waitcnt lgkmcnt(6)
    v_mfma_f32_32x32x16_bf16 v[0:15], v[152:155], v[136:139], v[0:15]
    ds_read_b128 v[104:107], v56 offset:43008
    ds_read_b128 v[120:123], v61 offset:12288
    s_add_u32 m0, s68, 81920
    s_nop 0
    buffer_load_dwordx4 v253, s[12:15], s64 offen lds
    s_waitcnt lgkmcnt(6)
    v_mfma_f32_32x32x16_bf16 v[0:15], v[156:159], v[140:143], v[0:15]
    ds_read_b128 v[108:111], v56 offset:44032
    ds_read_b128 v[124:127], v61 offset:14336
    buffer_load_dwordx4 v253, s[12:15], s64 offen offset:1024 lds
    s_add_u32 s64, s64, 8192
    s_waitcnt vmcnt(14)
    s_barrier
    s_waitcnt lgkmcnt(6)
    v_mfma_f32_32x32x16_bf16 v[0:15], v[112:115], v[96:99], v[0:15]
    ds_read_b128 v[128:131], v56 offset:49152
    ds_read_b128 v[144:147], v59 offset:0
    s_add_u32 m0, s65, 98304
    s_nop 0
    buffer_load_dwordx4 v253, s[12:15], s55 offen sc1 lds
    s_waitcnt lgkmcnt(6)
    v_mfma_f32_32x32x16_bf16 v[0:15], v[116:119], v[100:103], v[0:15]
    ds_read_b128 v[132:135], v56 offset:50176
    ds_read_b128 v[148:151], v59 offset:2048
    buffer_load_dwordx4 v253, s[12:15], s55 offen offset:1024 sc1 lds
    s_add_u32 s55, s55, 4096
    s_waitcnt lgkmcnt(6)
    v_mfma_f32_32x32x16_bf16 v[0:15], v[120:123], v[104:107], v[0:15]
    ds_read_b128 v[136:139], v56 offset:51200
    ds_read_b128 v[152:155], v59 offset:4096
    s_add_u32 m0, s68, 90112
    s_nop 0
    buffer_load_dwordx4 v253, s[12:15], s64 offen lds
    s_waitcnt lgkmcnt(6)
    v_mfma_f32_32x32x16_bf16 v[0:15], v[124:127], v[108:111], v[0:15]
    ds_read_b128 v[140:143], v56 offset:52224
    ds_read_b128 v[156:159], v59 offset:6144
    buffer_load_dwordx4 v253, s[12:15], s64 offen offset:1024 lds
    s_add_u32 s64, s64, 8192
    s_waitcnt vmcnt(16)
    s_barrier
    s_waitcnt lgkmcnt(6)
    v_mfma_f32_32x32x16_bf16 v[0:15], v[144:147], v[128:131], v[0:15]
    ds_read_b128 v[96:99], v57 offset:0
    ds_read_b128 v[112:115], v59 offset:8192
    s_add_u32 m0, s65, 106496
    s_nop 0
    buffer_load_dwordx4 v253, s[12:15], s55 offen sc1 lds
    s_waitcnt lgkmcnt(6)
    v_mfma_f32_32x32x16_bf16 v[0:15], v[148:151], v[132:135], v[0:15]
    ds_read_b128 v[100:103], v57 offset:1024
    ds_read_b128 v[116:119], v59 offset:10240
    buffer_load_dwordx4 v253, s[12:15], s55 offen offset:1024 sc1 lds
    s_add_u32 s55, s55, 4096
    s_waitcnt lgkmcnt(6)
    v_mfma_f32_32x32x16_bf16 v[0:15], v[152:155], v[136:139], v[0:15]
    ds_read_b128 v[104:107], v57 offset:2048
    ds_read_b128 v[120:123], v59 offset:12288
    s_add_u32 m0, s68, 32768
    s_nop 0
    buffer_load_dwordx4 v253, s[12:15], s64 offen lds
    s_waitcnt lgkmcnt(6)
    v_mfma_f32_32x32x16_bf16 v[0:15], v[156:159], v[140:143], v[0:15]
    ds_read_b128 v[108:111], v57 offset:3072
    ds_read_b128 v[124:127], v59 offset:14336
    buffer_load_dwordx4 v253, s[12:15], s64 offen offset:1024 lds
    s_add_u32 s64, s64, 8192
    s_waitcnt vmcnt(18)
    s_barrier
    s_waitcnt lgkmcnt(6)
    v_mfma_f32_32x32x16_bf16 v[0:15], v[112:115], v[96:99], v[0:15]
    ds_read_b128 v[128:131], v58 offset:16384
    ds_read_b128 v[144:147], v59 offset:16384
    s_add_u32 m0, s65, 114688
    s_nop 0
    buffer_load_dwordx4 v253, s[12:15], s55 offen sc1 lds
    s_waitcnt lgkmcnt(6)
    v_mfma_f32_32x32x16_bf16 v[0:15], v[116:119], v[100:103], v[0:15]
    ds_read_b128 v[132:135], v58 offset:17408
    ds_read_b128 v[148:151], v59 offset:18432
    buffer_load_dwordx4 v253, s[12:15], s55 offen offset:1024 sc1 lds
    s_add_u32 s55, s55, 4096
    s_waitcnt lgkmcnt(6)
    v_mfma_f32_32x32x16_bf16 v[0:15], v[120:123], v[104:107], v[0:15]
    ds_read_b128 v[136:139], v58 offset:18432
    ds_read_b128 v[152:155], v59 offset:20480
    s_add_u32 m0, s68, 40960
    s_nop 0
    buffer_load_dwordx4 v253, s[12:15], s64 offen lds
    s_waitcnt lgkmcnt(6)
    v_mfma_f32_32x32x16_bf16 v[0:15], v[124:127], v[108:111], v[0:15]
    ds_read_b128 v[140:143], v58 offset:19456
    ds_read_b128 v[156:159], v59 offset:22528
    buffer_load_dwordx4 v253, s[12:15], s64 offen offset:1024 lds
    s_add_u32 s64, s64, 8192
    s_waitcnt vmcnt(18)
    s_barrier
    s_waitcnt lgkmcnt(6)
    v_mfma_f32_32x32x16_bf16 v[0:15], v[144:147], v[128:131], v[0:15]
    ds_read_b128 v[96:99], v58 offset:24576
    ds_read_b128 v[112:115], v59 offset:24576
    s_add_u32 m0, s65, 122880
    s_nop 0
    buffer_load_dwordx4 v253, s[12:15], s55 offen sc1 lds
    s_waitcnt lgkmcnt(6)
    v_mfma_f32_32x32x16_bf16 v[0:15], v[148:151], v[132:135], v[0:15]
    ds_read_b128 v[100:103], v58 offset:25600
    ds_read_b128 v[116:119], v59 offset:26624
    buffer_load_dwordx4 v253, s[12:15], s55 offen offset:1024 sc1 lds
    s_add_u32 s55, s55, 4096
    s_waitcnt lgkmcnt(6)
    v_mfma_f32_32x32x16_bf16 v[0:15], v[152:155], v[136:139], v[0:15]
    ds_read_b128 v[104:107], v58 offset:26624
    ds_read_b128 v[120:123], v59 offset:28672
    s_add_u32 m0, s68, 49152
    s_nop 0
    buffer_load_dwordx4 v253, s[12:15], s64 offen lds
    s_waitcnt lgkmcnt(6)
    v_mfma_f32_32x32x16_bf16 v[0:15], v[156:159], v[140:143], v[0:15]
    ds_read_b128 v[108:111], v58 offset:27648
    ds_read_b128 v[124:127], v59 offset:30720
    buffer_load_dwordx4 v253, s[12:15], s64 offen offset:1024 lds
    s_add_u32 s64, s64, 8192
    s_waitcnt vmcnt(18) lgkmcnt(0)
    s_cmp_lg_u32 s70, 0
    s_cbranch_scc1 blk1_kernel_pok_9
    s_add_u32 s66, s8, s73
    s_addc_u32 s67, s9, 0
    s_mov_b32 s74, 0
blk1_kernel_poll_8:
    s_load_dword s16, s[66:67], 0 glc
    s_add_u32 s74, s74, 1
    s_waitcnt lgkmcnt(0)
    s_cmp_eq_u32 s16, 16
    s_cbranch_scc1 blk1_kernel_pok_9
    s_sleep 2
    s_cmp_lt_u32 s74, 0x40000
    s_cbranch_scc1 blk1_kernel_poll_8
blk1_kernel_pok_9:
    s_barrier
    s_waitcnt lgkmcnt(6)
    v_mfma_f32_32x32x16_bf16 v[0:15], v[112:115], v[96:99], v[0:15]
    ds_read_b128 v[128:131], v58 offset:32768
    ds_read_b128 v[144:147], v60 offset:8192
    s_add_u32 m0, s65, 0
    s_nop 0
    buffer_load_dwordx4 v253, s[12:15], s55 offen sc1 lds
    s_waitcnt lgkmcnt(6)
    v_mfma_f32_32x32x16_bf16 v[0:15], v[116:119], v[100:103], v[0:15]
    ds_read_b128 v[132:135], v58 offset:33792
    ds_read_b128 v[148:151], v60 offset:10240
    buffer_load_dwordx4 v253, s[12:15], s55 offen offset:1024 sc1 lds
    s_add_u32 s55, s55, 4096
    s_waitcnt lgkmcnt(6)
    v_mfma_f32_32x32x16_bf16 v[0:15], v[120:123], v[104:107], v[0:15]
    ds_read_b128 v[136:139], v58 offset:34816
    ds_read_b128 v[152:155], v60 offset:12288
    s_add_u32 m0, s68, 57344
    s_nop 0
    buffer_load_dwordx4 v253, s[12:15], s64 offen lds
    s_waitcnt lgkmcnt(6)
    v_mfma_f32_32x32x16_bf16 v[0:15], v[124:127], v[108:111], v[0:15]
    ds_read_b128 v[140:143], v58 offset:35840
    ds_read_b128 v[156:159], v60 offset:14336
    buffer_load_dwordx4 v253, s[12:15], s64 offen offset:1024 lds
    s_add_u32 s64, s64, 8192
    s_waitcnt vmcnt(18)
    s_barrier
    s_waitcnt lgkmcnt(6)
    v_mfma_f32_32x32x16_bf16 v[0:15], v[144:147], v[128:131], v[0:15]
    ds_read_b128 v[96:99], v57 offset:40960
    ds_read_b128 v[112:115], v60 offset:16384
    s_add_u32 m0, s65, 8192
    s_nop 0
    buffer_load_dwordx4 v253, s[12:15], s55 offen sc1 lds
    s_waitcnt lgkmcnt(6)
    v_mfma_f32_32x32x16_bf16 v[0:15], v[148:151], v[132:135], v[0:15]
    ds_read_b128 v[100:103], v57 offset:41984
    ds_read_b128 v[116:119], v60 offset:18432
    buffer_load_dwordx4 v253, s[12:15], s55 offen offset:1024 sc1 lds
    s_add_u32 s55, s55, 4096
    s_waitcnt lgkmcnt(6)
    v_mfma_f32_32x32x16_bf16 v[0:15], v[152:155], v[136:139], v[0:15]
    ds_read_b128 v[104:107], v57 offset:43008
    ds_read_b128 v[120:123], v60 offset:20480
    s_add_u32 m0, s68, 131072
    s_nop 0
    buffer_load_dwordx4 v253, s[12:15], s64 offen lds
    s_waitcnt lgkmcnt(6)
    v_mfma_f32_32x32x16_bf16 v[0:15], v[156:159], v[140:143], v[0:15]
    ds_read_b128 v[108:111], v57 offset:44032
    ds_read_b128 v[124:127], v60 offset:22528
    buffer_load_dwordx4 v253, s[12:15], s64 offen offset:1024 lds
    s_add_u32 s64, s64, 8192
    s_waitcnt vmcnt(18)
    s_barrier
    s_waitcnt lgkmcnt(6)
    v_mfma_f32_32x32x16_bf16 v[0:15], v[112:115], v[96:99], v[0:15]
    ds_read_b128 v[128:131], v57 offset:49152
    ds_read_b128 v[144:147], v60 offset:24576
    s_add_u32 m0, s65, 16384
    s_nop 0
    buffer_load_dwordx4 v253, s[12:15], s55 offen sc1 lds
    s_waitcnt lgkmcnt(6)
    v_mfma_f32_32x32x16_bf16 v[0:15], v[116:119], v[100:103], v[0:15]
    ds_read_b128 v[132:135], v57 offset:50176
    ds_read_b128 v[148:151], v60 offset:26624
    buffer_load_dwordx4 v253, s[12:15], s55 offen offset:1024 sc1 lds
    s_add_u32 s55, s55, 4096
    s_waitcnt lgkmcnt(6)
    v_mfma_f32_32x32x16_bf16 v[0:15], v[120:123], v[104:107], v[0:15]
    ds_read_b128 v[136:139], v57 offset:51200
    ds_read_b128 v[152:155], v60 offset:28672
    s_add_u32 m0, s68, 139264
    s_nop 0
    buffer_load_dwordx4 v253, s[12:15], s64 offen lds
    s_waitcnt lgkmcnt(6)
    v_mfma_f32_32x32x16_bf16 v[0:15], v[124:127], v[108:111], v[0:15]
    ds_read_b128 v[140:143], v57 offset:52224
    ds_read_b128 v[156:159], v60 offset:30720
    buffer_load_dwordx4 v253, s[12:15], s64 offen offset:1024 lds
    s_add_u32 s64, s64, 8192
    s_waitcnt vmcnt(18)
    s_barrier
    s_waitcnt lgkmcnt(6)
    v_mfma_f32_32x32x16_bf16 v[0:15], v[144:147], v[128:131], v[0:15]
    ds_read_b128 v[96:99], v58 offset:0
    ds_read_b128 v[112:115], v60 offset:32768
    s_add_u32 m0, s65, 24576
    s_nop 0
    buffer_load_dwordx4 v253, s[12:15], s55 offen sc1 lds
    s_waitcnt lgkmcnt(6)
    v_mfma_f32_32x32x16_bf16 v[0:15], v[148:151], v[132:135], v[0:15]
    ds_read_b128 v[100:103], v58 offset:1024
    ds_read_b128 v[116:119], v60 offset:34816
    buffer_load_dwordx4 v253, s[12:15], s55 offen offset:1024 sc1 lds
    s_add_u32 s55, s55, 4096
    s_waitcnt lgkmcnt(6)
    v_mfma_f32_32x32x16_bf16 v[0:15], v[152:155], v[136:139], v[0:15]
    ds_read_b128 v[104:107], v58 offset:2048
    ds_read_b128 v[120:123], v60 offset:36864
    s_add_u32 m0, s68, 147456
    s_nop 0
    buffer_load_dwordx4 v253, s[12:15], s64 offen lds
    s_waitcnt lgkmcnt(6)
    v_mfma_f32_32x32x16_bf16 v[0:15], v[156:159], v[140:143], v[0:15]
    ds_read_b128 v[108:111], v58 offset:3072
    ds_read_b128 v[124:127], v60 offset:38912
    buffer_load_dwordx4 v253, s[12:15], s64 offen offset:1024 lds
    s_add_u32 s64, s64, 8192
    s_waitcnt vmcnt(18)
    s_barrier
    s_waitcnt lgkmcnt(6)
    v_mfma_f32_32x32x16_bf16 v[0:15], v[112:115], v[96:99], v[0:15]
    ds_read_b128 v[128:131], v58 offset:8192
    ds_read_b128 v[144:147], v59 offset:32768
    s_add_u32 m0, s65, 65536
    s_nop 0
    buffer_load_dwordx4 v253, s[12:15], s55 offen sc1 lds
    s_waitcnt lgkmcnt(6)
    v_mfma_f32_32x32x16_bf16 v[0:15], v[116:119], v[100:103], v[0:15]
    ds_read_b128 v[132:135], v58 offset:9216
    ds_read_b128 v[148:151], v59 offset:34816
    buffer_load_dwordx4 v253, s[12:15], s55 offen offset:1024 sc1 lds
    s_add_u32 s55, s55, 4096
    s_waitcnt lgkmcnt(6)
    v_mfma_f32_32x32x16_bf16 v[0:15], v[120:123], v[104:107], v[0:15]
    ds_read_b128 v[136:139], v58 offset:10240
    ds_read_b128 v[152:155], v59 offset:36864
    s_add_u32 m0, s68, 98304
    s_nop 0
    buffer_load_dwordx4 v253, s[12:15], s64 offen lds
    s_waitcnt lgkmcnt(6)
    v_mfma_f32_32x32x16_bf16 v[0:15], v[124:127], v[108:111], v[0:15]
    ds_read_b128 v[140:143], v58 offset:11264
    ds_read_b128 v[156:159], v59 offset:38912
    buffer_load_dwordx4 v253, s[12:15], s64 offen offset:1024 lds
    s_add_u32 s64, s64, 8192
    s_waitcnt vmcnt(18)
    s_barrier
    s_waitcnt lgkmcnt(6)
    v_mfma_f32_32x32x16_bf16 v[0:15], v[144:147], v[128:131], v[0:15]
    ds_read_b128 v[96:99], v56 offset:0
    ds_read_b128 v[112:115], v59 offset:40960
    s_add_u32 m0, s65, 73728
    s_nop 0
    buffer_load_dwordx4 v253, s[12:15], s55 offen sc1 lds
    s_waitcnt lgkmcnt(6)
    v_mfma_f32_32x32x16_bf16 v[0:15], v[148:151], v[132:135], v[0:15]
    ds_read_b128 v[100:103], v56 offset:1024
    ds_read_b128 v[116:119], v59 offset:43008
    buffer_load_dwordx4 v253, s[12:15], s55 offen offset:1024 sc1 lds
    s_add_u32 s55, s55, 4096
    s_waitcnt lgkmcnt(6)
    v_mfma_f32_32x32x16_bf16 v[0:15], v[152:155], v[136:139], v[0:15]
    ds_read_b128 v[104:107], v56 offset:2048
    ds_read_b128 v[120:123], v59 offset:45056
    s_add_u32 m0, s68, 106496
    s_nop 0
    buffer_load_dwordx4 v253, s[12:15], s64 offen lds
    s_waitcnt lgkmcnt(6)
    v_mfma_f32_32x32x16_bf16 v[0:15], v[156:159], v[140:143], v[0:15]
    ds_read_b128 v[108:111], v56 offset:3072
    ds_read_b128 v[124:127], v59 offset:47104
    buffer_load_dwordx4 v253, s[12:15], s64 offen offset:1024 lds
    s_add_u32 s64, s64, 8192
    s_waitcnt vmcnt(18)
    s_barrier
    s_waitcnt lgkmcnt(6)
    v_mfma_f32_32x32x16_bf16 v[0:15], v[112:115], v[96:99], v[0:15]
    ds_read_b128 v[128:131], v56 offset:8192
    ds_read_b128 v[144:147], v59 offset:49152
    s_add_u32 m0, s65, 81920
    s_nop 0
    buffer_load_dwordx4 v253, s[12:15], s55 offen sc1 lds
    s_waitcnt lgkmcnt(6)
    v_mfma_f32_32x32x16_bf16 v[0:15], v[116:119], v[100:103], v[0:15]
    ds_read_b128 v[132:135], v56 offset:9216
    ds_read_b128 v[148:151], v59 offset:51200
    buffer_load_dwordx4 v253, s[12:15], s55 offen offset:1024 sc1 lds
    s_add_u32 s55, s55, 4096
    s_waitcnt lgkmcnt(6)
    v_mfma_f32_32x32x16_bf16 v[0:15], v[120:123], v[104:107], v[0:15]
    ds_read_b128 v[136:139], v56 offset:10240
    ds_read_b128 v[152:155], v59 offset:53248
    s_add_u32 m0, s68, 114688
    s_nop 0
    buffer_load_dwordx4 v253, s[12:15], s64 offen lds
    s_waitcnt lgkmcnt(6)
    v_mfma_f32_32x32x16_bf16 v[0:15], v[124:127], v[108:111], v[0:15]
    ds_read_b128 v[140:143], v56 offset:11264
    ds_read_b128 v[156:159], v59 offset:55296
    buffer_load_dwordx4 v253, s[12:15], s64 offen offset:1024 lds
    s_add_u32 s64, s64, 8192
    s_waitcnt vmcnt(18)
    s_barrier
    s_waitcnt lgkmcnt(6)
    v_mfma_f32_32x32x16_bf16 v[0:15], v[144:147], v[128:131], v[0:15]
    ds_read_b128 v[96:99], v56 offset:16384
    ds_read_b128 v[112:115], v60 offset:0
    s_add_u32 m0, s65, 90112
    s_nop 0
    buffer_load_dwordx4 v253, s[12:15], s55 offen sc1 lds
    s_waitcnt lgkmcnt(6)
    v_mfma_f32_32x32x16_bf16 v[0:15], v[148:151], v[132:135], v[0:15]
    ds_read_b128 v[100:103], v56 offset:17408
    ds_read_b128 v[116:119], v60 offset:2048
    buffer_load_dwordx4 v253, s[12:15], s55 offen offset:1024 sc1 lds
    s_add_u32 s55, s55, 4096
    s_waitcnt lgkmcnt(6)
    v_mfma_f32_32x32x16_bf16 v[0:15], v[152:155], v[136:139], v[0:15]
    ds_read_b128 v[104:107], v56 offset:18432
    ds_read_b128 v[120:123], v60 offset:4096
    s_add_u32 m0, s68, 122880
    s_nop 0
    buffer_load_dwordx4 v253, s[12:15], s64 offen lds
    s_waitcnt lgkmcnt(6)
    v_mfma_f32_32x32x16_bf16 v[0:15], v[156:159], v[140:143], v[0:15]
    ds_read_b128 v[108:111], v56 offset:19456
    ds_read_b128 v[124:127], v60 offset:6144
    buffer_load_dwordx4 v253, s[12:15], s64 offen offset:1024 lds
    s_add_u32 s64, s64, 8192
    s_waitcnt vmcnt(18)
    s_barrier
    s_waitcnt lgkmcnt(6)
    v_mfma_f32_32x32x16_bf16 v[0:15], v[112:115], v[96:99], v[0:15]
    ds_read_b128 v[128:131], v56 offset:24576
    ds_read_b128 v[144:147], v61 offset:16384
    s_add_u32 m0, s65, 32768
    s_nop 0
    buffer_load_dwordx4 v253, s[12:15], s55 offen sc1 lds
    s_waitcnt lgkmcnt(6)
    v_mfma_f32_32x32x16_bf16 v[0:15], v[116:119], v[100:103], v[0:15]
    ds_read_b128 v[132:135], v56 offset:25600
    ds_read_b128 v[148:151], v61 offset:18432
    buffer_load_dwordx4 v253, s[12:15], s55 offen offset:1024 sc1 lds
    s_add_u32 s55, s55, 4096
    s_waitcnt lgkmcnt(6)
    v_mfma_f32_32x32x16_bf16 v[0:15], v[120:123], v[104:107], v[0:15]
    ds_read_b128 v[136:139], v56 offset:26624
    ds_read_b128 v[152:155], v61 offset:20480
    s_add_u32 m0, s68, 0
    s_nop 0
    buffer_load_dwordx4 v253, s[12:15], s64 offen lds
    s_waitcnt lgkmcnt(6)
    v_mfma_f32_32x32x16_bf16 v[0:15], v[124:127], v[108:111], v[0:15]
    ds_read_b128 v[140:143], v56 offset:27648
    ds_read_b128 v[156:159], v61 offset:22528
    buffer_load_dwordx4 v253, s[12:15], s64 offen offset:1024 lds
    s_add_u32 s64, s64, 8192
    s_waitcnt vmcnt(18)
    s_barrier
    s_waitcnt lgkmcnt(6)
    v_mfma_f32_32x32x16_bf16 v[0:15], v[144:147], v[128:131], v[0:15]
    ds_read_b128 v[96:99], v57 offset:8192
    ds_read_b128 v[112:115], v61 offset:24576
    s_add_u32 m0, s65, 40960
    s_nop 0
    buffer_load_dwordx4 v253, s[12:15], s55 offen sc1 lds
    s_waitcnt lgkmcnt(6)
    v_mfma_f32_32x32x16_bf16 v[0:15], v[148:151], v[132:135], v[0:15]
    ds_read_b128 v[100:103], v57 offset:9216
    ds_read_b128 v[116:119], v61 offset:26624
    buffer_load_dwordx4 v253, s[12:15], s55 offen offset:1024 sc1 lds
    s_add_u32 s55, s55, 4096
    s_waitcnt lgkmcnt(6)
    v_mfma_f32_32x32x16_bf16 v[0:15], v[152:155], v[136:139], v[0:15]
    ds_read_b128 v[104:107], v57 offset:10240
    ds_read_b128 v[120:123], v61 offset:28672
    s_add_u32 m0, s68, 8192
    s_nop 0
    buffer_load_dwordx4 v253, s[12:15], s64 offen lds
    s_waitcnt lgkmcnt(6)
    v_mfma_f32_32x32x16_bf16 v[0:15], v[156:159], v[140:143], v[0:15]
    ds_read_b128 v[108:111], v57 offset:11264
    ds_read_b128 v[124:127], v61 offset:30720
    buffer_load_dwordx4 v253, s[12:15], s64 offen offset:1024 lds
    s_add_u32 s64, s64, 8192
    s_waitcnt vmcnt(18)
    s_barrier
    s_waitcnt lgkmcnt(6)
    v_mfma_f32_32x32x16_bf16 v[0:15], v[112:115], v[96:99], v[0:15]
    ds_read_b128 v[128:131], v57 offset:16384
    ds_read_b128 v[144:147], v61 offset:32768
    s_add_u32 m0, s65, 49152
    s_nop 0
    buffer_load_dwordx4 v253, s[12:15], s55 offen sc1 lds
    s_waitcnt lgkmcnt(6)
    v_mfma_f32_32x32x16_bf16 v[0:15], v[116:119], v[100:103], v[0:15]
    ds_read_b128 v[132:135], v57 offset:17408
    ds_read_b128 v[148:151], v61 offset:34816
    buffer_load_dwordx4 v253, s[12:15], s55 offen offset:1024 sc1 lds
    s_add_u32 s55, s55, 4096
    s_waitcnt lgkmcnt(6)
    v_mfma_f32_32x32x16_bf16 v[0:15], v[120:123], v[104:107], v[0:15]
    ds_read_b128 v[136:139], v57 offset:18432
    ds_read_b128 v[152:155], v61 offset:36864
    s_waitcnt lgkmcnt(6)
    v_mfma_f32_32x32x16_bf16 v[0:15], v[124:127], v[108:111], v[0:15]
    ds_read_b128 v[140:143], v57 offset:19456
    ds_read_b128 v[156:159], v61 offset:38912
    s_waitcnt vmcnt(16)
    s_barrier
    s_waitcnt lgkmcnt(6)
    v_mfma_f32_32x32x16_bf16 v[0:15], v[144:147], v[128:131], v[0:15]
    ds_read_b128 v[96:99], v57 offset:24576
    ds_read_b128 v[112:115], v60 offset:40960
    s_add_u32 m0, s65, 16384
    s_nop 0
    buffer_load_dwordx4 v253, s[12:15], s55 offen sc1 lds
    s_waitcnt lgkmcnt(6)
    v_mfma_f32_32x32x16_bf16 v[0:15], v[148:151], v[132:135], v[0:15]
    ds_read_b128 v[100:103], v57 offset:25600
    ds_read_b128 v[116:119], v60 offset:43008
    buffer_load_dwordx4 v253, s[12:15], s55 offen offset:1024 sc1 lds
    s_add_u32 s55, s55, 4096
    s_waitcnt lgkmcnt(6)
    v_mfma_f32_32x32x16_bf16 v[0:15], v[152:155], v[136:139], v[0:15]
    ds_read_b128 v[104:107], v57 offset:26624
    ds_read_b128 v[120:123], v60 offset:45056
    s_waitcnt lgkmcnt(6)
    v_mfma_f32_32x32x16_bf16 v[0:15], v[156:159], v[140:143], v[0:15]
    ds_read_b128 v[108:111], v57 offset:27648
    ds_read_b128 v[124:127], v60 offset:47104
    s_waitcnt vmcnt(14)
    s_barrier
    s_waitcnt lgkmcnt(6)
    v_mfma_f32_32x32x16_bf16 v[0:15], v[112:115], v[96:99], v[0:15]
    ds_read_b128 v[128:131], v57 offset:32768
    ds_read_b128 v[144:147], v60 offset:49152
    s_waitcnt lgkmcnt(6)
    v_mfma_f32_32x32x16_bf16 v[0:15], v[116:119], v[100:103], v[0:15]
    ds_read_b128 v[132:135], v57 offset:33792
    ds_read_b128 v[148:151], v60 offset:51200
    s_waitcnt lgkmcnt(6)
    v_mfma_f32_32x32x16_bf16 v[0:15], v[120:123], v[104:107], v[0:15]
    ds_read_b128 v[136:139], v57 offset:34816
    ds_read_b128 v[152:155], v60 offset:53248
    s_waitcnt lgkmcnt(6)
    v_mfma_f32_32x32x16_bf16 v[0:15], v[124:127], v[108:111], v[0:15]
    ds_read_b128 v[140:143], v57 offset:35840
    ds_read_b128 v[156:159], v60 offset:55296
    s_waitcnt vmcnt(10)
    s_barrier
    s_waitcnt lgkmcnt(6)
    v_mfma_f32_32x32x16_bf16 v[0:15], v[144:147], v[128:131], v[0:15]
    ds_read_b128 v[96:99], v56 offset:32768
    ds_read_b128 v[112:115], v61 offset:0
    s_waitcnt lgkmcnt(6)
    v_mfma_f32_32x32x16_bf16 v[0:15], v[148:151], v[132:135], v[0:15]
    ds_read_b128 v[100:103], v56 offset:33792
    ds_read_b128 v[116:119], v61 offset:2048
    s_waitcnt lgkmcnt(6)
    v_mfma_f32_32x32x16_bf16 v[0:15], v[152:155], v[136:139], v[0:15]
    ds_read_b128 v[104:107], v56 offset:34816
    ds_read_b128 v[120:123], v61 offset:4096
    s_waitcnt lgkmcnt(6)
    v_mfma_f32_32x32x16_bf16 v[0:15], v[156:159], v[140:143], v[0:15]
    ds_read_b128 v[108:111], v56 offset:35840
    ds_read_b128 v[124:127], v61 offset:6144
    s_waitcnt vmcnt(6)
    s_barrier
    s_waitcnt lgkmcnt(6)
    v_mfma_f32_32x32x16_bf16 v[0:15], v[112:115], v[96:99], v[0:15]
    ds_read_b128 v[128:131], v56 offset:40960
    ds_read_b128 v[144:147], v61 offset:8192
    s_waitcnt lgkmcnt(6)
    v_mfma_f32_32x32x16_bf16 v[0:15], v[116:119], v[100:103], v[0:15]
    ds_read_b128 v[132:135], v56 offset:41984
    ds_read_b128 v[148:151], v61 offset:10240
    s_waitcnt lgkmcnt(6)
    v_mfma_f32_32x32x16_bf16 v[0:15], v[120:123], v[104:107], v[0:15]
    ds_read_b128 v[136:139], v56 offset:43008
    ds_read_b128 v[152:155], v61 offset:12288
    s_waitcnt lgkmcnt(6)
    v_mfma_f32_32x32x16_bf16 v[0:15], v[124:127], v[108:111], v[0:15]
    ds_read_b128 v[140:143], v56 offset:44032
    ds_read_b128 v[156:159], v61 offset:14336
    s_waitcnt vmcnt(2)
    s_barrier
    s_waitcnt lgkmcnt(6)
    v_mfma_f32_32x32x16_bf16 v[0:15], v[144:147], v[128:131], v[0:15]
    ds_read_b128 v[96:99], v56 offset:49152
    ds_read_b128 v[112:115], v59 offset:0
    s_waitcnt lgkmcnt(6)
    v_mfma_f32_32x32x16_bf16 v[0:15], v[148:151], v[132:135], v[0:15]
    ds_read_b128 v[100:103], v56 offset:50176
    ds_read_b128 v[116:119], v59 offset:2048
    s_waitcnt lgkmcnt(6)
    v_mfma_f32_32x32x16_bf16 v[0:15], v[152:155], v[136:139], v[0:15]
    ds_read_b128 v[104:107], v56 offset:51200
    ds_read_b128 v[120:123], v59 offset:4096
    s_waitcnt lgkmcnt(6)
    v_mfma_f32_32x32x16_bf16 v[0:15], v[156:159], v[140:143], v[0:15]
    ds_read_b128 v[108:111], v56 offset:52224
    ds_read_b128 v[124:127], v59 offset:6144
    s_waitcnt vmcnt(0)
    s_barrier
    s_waitcnt lgkmcnt(6)
    v_mfma_f32_32x32x16_bf16 v[0:15], v[112:115], v[96:99], v[0:15]
    ds_read_b128 v[128:131], v56 offset:16384
    ds_read_b128 v[144:147], v59 offset:8192
    s_waitcnt lgkmcnt(6)
    v_mfma_f32_32x32x16_bf16 v[0:15], v[116:119], v[100:103], v[0:15]
    ds_read_b128 v[132:135], v56 offset:17408
    ds_read_b128 v[148:151], v59 offset:10240
    s_waitcnt lgkmcnt(6)
    v_mfma_f32_32x32x16_bf16 v[0:15], v[120:123], v[104:107], v[0:15]
    ds_read_b128 v[136:139], v56 offset:18432
    ds_read_b128 v[152:155], v59 offset:12288
    s_waitcnt lgkmcnt(6)
    v_mfma_f32_32x32x16_bf16 v[0:15], v[124:127], v[108:111], v[0:15]
    ds_read_b128 v[140:143], v56 offset:19456
    ds_read_b128 v[156:159], v59 offset:14336
    s_waitcnt lgkmcnt(6)
    v_mfma_f32_32x32x16_bf16 v[0:15], v[144:147], v[128:131], v[0:15]
    s_waitcnt lgkmcnt(4)
    v_mfma_f32_32x32x16_bf16 v[0:15], v[148:151], v[132:135], v[0:15]
    s_waitcnt lgkmcnt(2)
    v_mfma_f32_32x32x16_bf16 v[0:15], v[152:155], v[136:139], v[0:15]
    s_waitcnt lgkmcnt(0)
    v_mfma_f32_32x32x16_bf16 v[0:15], v[156:159], v[140:143], v[0:15]
    s_barrier
    s_mov_b32 s47, 0xffff0000
    v_lshlrev_b32 v80, 16, v48
    v_and_b32 v81, s47, v48
    v_lshlrev_b32 v82, 16, v49
    v_and_b32 v83, s47, v49
    v_lshlrev_b32 v84, 16, v50
    v_and_b32 v85, s47, v50
    v_lshlrev_b32 v86, 16, v51
    v_and_b32 v87, s47, v51
    v_lshlrev_b32 v88, 16, v52
    v_and_b32 v89, s47, v52
    v_lshlrev_b32 v90, 16, v53
    v_and_b32 v91, s47, v53
    v_lshlrev_b32 v92, 16, v54
    v_and_b32 v93, s47, v54
    v_lshlrev_b32 v94, 16, v55
    v_and_b32 v95, s47, v55
    v_fma_f32 v0, v0, v73, v80
    v_fma_f32 v1, v1, v73, v81
    v_fma_f32 v2, v2, v73, v82
    v_fma_f32 v3, v3, v73, v83
    v_fma_f32 v4, v4, v73, v84
    v_fma_f32 v5, v5, v73, v85
    v_fma_f32 v6, v6, v73, v86
    v_fma_f32 v7, v7, v73, v87
    v_fma_f32 v8, v8, v73, v88
    v_fma_f32 v9, v9, v73, v89
    v_fma_f32 v10, v10, v73, v90
    v_fma_f32 v11, v11, v73, v91
    v_fma_f32 v12, v12, v73, v92
    v_fma_f32 v13, v13, v73, v93
    v_fma_f32 v14, v14, v73, v94
    v_fma_f32 v15, v15, v73, v95
    v_cvt_pk_bf16_f32 v48, v0, v1
    v_cvt_pk_bf16_f32 v49, v2, v3
    v_cvt_pk_bf16_f32 v50, v4, v5
    v_cvt_pk_bf16_f32 v51, v6, v7
    v_cvt_pk_bf16_f32 v52, v8, v9
    v_cvt_pk_bf16_f32 v53, v10, v11
    v_cvt_pk_bf16_f32 v54, v12, v13
    v_cvt_pk_bf16_f32 v55, v14, v15
    s_cmp_lg_u32 s71, 0
    s_cbranch_scc1 blk1_kernel_nat
    s_add_u32 s58, s57, 12582912
    buffer_store_dwordx4 v[48:51], v253, s[12:15], s58 offen sc1
    buffer_store_dwordx4 v[52:55], v253, s[12:15], s58 offen offset:1024 sc1
    v_and_b32 v64, 31, v252
    v_lshlrev_b32 v64, 3, v64
    s_lshr_b32 s58, s57, 3
    s_add_u32 s58, s58, 7340032
    v_lshlrev_b32 v80, 16, v48
    v_and_b32 v81, s47, v48
    v_lshlrev_b32 v82, 16, v49
    v_and_b32 v83, s47, v49
    v_lshlrev_b32 v84, 16, v50
    v_and_b32 v85, s47, v50
    v_lshlrev_b32 v86, 16, v51
    v_and_b32 v87, s47, v51
    v_lshlrev_b32 v88, 16, v52
    v_and_b32 v89, s47, v52
    v_lshlrev_b32 v90, 16, v53
    v_and_b32 v91, s47, v53
    v_lshlrev_b32 v92, 16, v54
    v_and_b32 v93, s47, v54
    v_lshlrev_b32 v94, 16, v55
    v_and_b32 v95, s47, v55
    v_add_f32 v66, v80, v81
    v_mul_f32 v67, v80, v80
    v_fmac_f32 v67, v81, v81
    v_add_f32 v66, v66, v82
    v_fmac_f32 v67, v82, v82
    v_add_f32 v66, v66, v83
    v_fmac_f32 v67, v83, v83
    v_add_f32 v66, v66, v84
    v_fmac_f32 v67, v84, v84
    v_add_f32 v66, v66, v85
    v_fmac_f32 v67, v85, v85
    v_add_f32 v66, v66, v86
    v_fmac_f32 v67, v86, v86
    v_add_f32 v66, v66, v87
    v_fmac_f32 v67, v87, v87
    v_add_f32 v66, v66, v88
    v_fmac_f32 v67, v88, v88
    v_add_f32 v66, v66, v89
    v_fmac_f32 v67, v89, v89
    v_add_f32 v66, v66, v90
    v_fmac_f32 v67, v90, v90
    v_add_f32 v66, v66, v91
    v_fmac_f32 v67, v91, v91
    v_add_f32 v66, v66, v92
    v_fmac_f32 v67, v92, v92
    v_add_f32 v66, v66, v93
    v_fmac_f32 v67, v93, v93
    v_add_f32 v66, v66, v94
    v_fmac_f32 v67, v94, v94
    v_add_f32 v66, v66, v95
    v_fmac_f32 v67, v95, v95
    v_mov_b32 v68, v66
    v_mov_b32 v69, v67
    s_nop 1
    v_permlane32_swap_b32 v66, v68
    v_permlane32_swap_b32 v67, v69
    s_nop 1
    v_add_f32 v66, v66, v68
    v_add_f32 v67, v67, v69
    s_mov_b64 exec, 0xffffffff
    buffer_store_dwordx2 v[66:67], v64, s[12:15], s58 offen sc1
    s_mov_b64 exec, -1
    s_lshr_b32 s58, s50, 1
    s_lshl_b32 s58, s58, 7
    s_and_b32 s59, s50, 1
    s_lshl_b32 s59, s59, 3
    s_add_u32 s59, s59, s51
    s_add_u32 s72, s58, s59
    s_add_u32 s72, s72, 36708352
    s_and_b32 s34, s2, 7
    s_lshr_b32 s35, s2, 3
    s_and_b32 s24, s34, 3
    s_lshl_b32 s24, s24, 2
    s_lshr_b32 s25, s34, 2
    s_lshl_b32 s25, s25, 3
    s_and_b32 s34, s35, 3
    s_add_u32 s24, s24, s34
    s_lshr_b32 s35, s35, 2
    s_add_u32 s25, s25, s35
    s_lshl_b32 s27, s24, 2
    s_add_u32 s27, s27, s70
    s_mul_i32 s30, s70, 3072
    s_mul_i32 s31, s25, 98304
    s_add_u32 s31, s31, s30
    s_add_u32 s31, s31, 27262976
    s_lshl_b32 s32, s27, 15
    s_add_u32 s32, s32, 12582912
    s_lshl_b32 s73, s24, 7
    s_add_u32 s73, s73, 36708352
    s_mov_b32 m0, s30
    s_add_u32 s30, s30, 12288
    buffer_load_dwordx4 v253, s[12:15], s31 offen offset:0 lds
    buffer_load_dwordx4 v253, s[12:15], s31 offen offset:1024 lds
    buffer_load_dwordx4 v253, s[12:15], s31 offen offset:2048 lds
    s_add_u32 s31, s31, 12288
    s_mov_b32 m0, s30
    s_add_u32 s30, s30, 12288
    buffer_load_dwordx4 v253, s[12:15], s31 offen offset:0 lds
    buffer_load_dwordx4 v253, s[12:15], s31 offen offset:1024 lds
    buffer_load_dwordx4 v253, s[12:15], s31 offen offset:2048 lds
    s_add_u32 s31, s31, 12288
    s_waitcnt vmcnt(6)
    s_barrier
    s_cmp_lg_u32 s70, 0
    s_cbranch_scc1 blk1_kernel_sig_10
    v_mov_b32 v254, 0
    v_mov_b32 v255, 1
    s_mov_b64 exec, 1
    s_and_b32 s72, s72, 0xffffff80
    buffer_atomic_add v255, v254, s[12:15], s72 offen sc1
    s_mov_b64 exec, -1
blk1_kernel_sig_10:
    v_and_b32 v232, 31, v252
    v_lshrrev_b32 v233, 5, v252
    v_lshlrev_b32 v234, 11, v233
    v_lshl_add_u32 v234, v232, 3, v234
    s_lshl_b32 s34, s27, 12
    s_add_u32 s34, s34, 7340032
    s_lshl_b32 s36, s70, 6
    v_add_u32 v235, s36, v252
    v_lshlrev_b32 v245, 5, v235
    s_mul_i32 s35, s25, 3072
    s_add_u32 s35, s35, 6619136
    s_mov_b32 m0, s30
    s_add_u32 s30, s30, 12288
    buffer_load_dwordx4 v253, s[12:15], s31 offen offset:0 lds
    buffer_load_dwordx4 v253, s[12:15], s31 offen offset:1024 lds
    buffer_load_dwordx4 v253, s[12:15], s31 offen offset:2048 lds
    s_add_u32 s31, s31, 12288
    s_mov_b32 m0, s30
    s_add_u32 s30, s30, 12288
    buffer_load_dwordx4 v253, s[12:15], s31 offen offset:0 lds
    buffer_load_dwordx4 v253, s[12:15], s31 offen offset:1024 lds
    buffer_load_dwordx4 v253, s[12:15], s31 offen offset:2048 lds
    s_add_u32 s31, s31, 12288
    s_mov_b32 m0, s30
    s_add_u32 s30, s30, 12288
    buffer_load_dwordx4 v253, s[12:15], s31 offen offset:0 lds
    buffer_load_dwordx4 v253, s[12:15], s31 offen offset:1024 lds
    buffer_load_dwordx4 v253, s[12:15], s31 offen offset:2048 lds
    s_add_u32 s31, s31, 12288
    s_mov_b32 m0, s30
    s_add_u32 s30, s30, 12288
    buffer_load_dwordx4 v253, s[12:15], s31 offen offset:0 lds
    buffer_load_dwordx4 v253, s[12:15], s31 offen offset:1024 lds
    buffer_load_dwordx4 v253, s[12:15], s31 offen offset:2048 lds
    s_add_u32 s31, s31, 12288
    s_mov_b32 m0, s30
    s_add_u32 s30, s30, 12288
    buffer_load_dwordx4 v253, s[12:15], s31 offen offset:0 lds
    buffer_load_dwordx4 v253, s[12:15], s31 offen offset:1024 lds
    buffer_load_dwordx4 v253, s[12:15], s31 offen offset:2048 lds
    s_add_u32 s31, s31, 12288
    s_mov_b32 m0, s30
    s_add_u32 s30, s30, 12288
    buffer_load_dwordx4 v253, s[12:15], s31 offen offset:0 lds
    buffer_load_dwordx4 v253, s[12:15], s31 offen offset:1024 lds
    buffer_load_dwordx4 v253, s[12:15], s31 offen offset:2048 lds
    s_add_u32 s31, s31, 12288
    v_mov_b32 v230, v253
    v_add_u32 v231, 49152, v253
    v_lshlrev_b32 v235, 2, v235
    v_add_u32 v235, 156672, v235
    s_lshl_b32 s36, s70, 8
    s_add_u32 s35, s36, 157696
    v_lshl_add_u32 v236, v232, 2, s35
    v_lshl_add_u32 v237, v233, 4, s35
    v_lshlrev_b32 v238, 4, v233
    v_add_u32 v238, 156672, v238
    v_lshlrev_b32 v239, 2, v232
    v_add_u32 v239, 156928, v239
    v_bfe_u32 v242, v252, 4, 1
    v_lshlrev_b32 v242, 16, v242
    v_and_b32 v243, 15, v252
    v_lshlrev_b32 v243, 4, v243
    v_lshlrev_b32 v244, 8, v233
    v_add3_u32 v242, v242, v243, v244
    v_lshrrev_b32 v243, 2, v252
    s_lshl_b32 s37, s25, 17
    s_lshl_b32 s38, s27, 10
    s_add_u32 s37, s37, s38
    s_add_u32 s39, s37, 4194304
    s_add_u32 s40, s37, 0
    s_add_u32 s41, s40, 65536
    s_add_u32 s42, s37, 2097152
    s_add_u32 s43, s42, 65536
    s_lshl_b32 s44, s25, 10
    s_lshl_b32 s45, s27, 3
    s_add_u32 s44, s44, s45
    s_add_u32 s44, s44, 6291456
    s_waitcnt vmcnt(18)
    ds_read_b128 v[84:87], v238 offset:0
    ds_read_b128 v[100:103], v238 offset:128
    ds_read_b128 v[88:91], v238 offset:32
    ds_read_b128 v[104:107], v238 offset:160
    ds_read_b128 v[92:95], v238 offset:64
    ds_read_b128 v[108:111], v238 offset:192
    ds_read_b128 v[96:99], v238 offset:96
    ds_read_b128 v[112:115], v238 offset:224
    ds_read_b32 v241, v239
    s_cmp_lg_u32 s70, 0
    s_cbranch_scc1 blk1_kernel_pok_12
    s_add_u32 s66, s8, s73
    s_addc_u32 s67, s9, 0
    s_mov_b32 s74, 0
blk1_kernel_poll_11:
    s_load_dword s16, s[66:67], 0 glc
    s_add_u32 s74, s74, 1
    s_waitcnt lgkmcnt(0)
    s_cmp_eq_u32 s16, 16
    s_cbranch_scc1 blk1_kernel_pok_12
    s_sleep 2
    s_cmp_lt_u32 s74, 0x40000
    s_cbranch_scc1 blk1_kernel_poll_11
blk1_kernel_pok_12:
    s_barrier
    buffer_load_dwordx4 v[148:151], v253, s[12:15], s32 offen offset:0 sc1
    buffer_load_dwordx4 v[152:155], v253, s[12:15], s32 offen offset:1024 sc1
    buffer_load_dwordx4 v[156:159], v253, s[12:15], s32 offen offset:2048 sc1
    buffer_load_dwordx4 v[160:163], v253, s[12:15], s32 offen offset:3072 sc1
    s_add_u32 s32, s32, 4096
    buffer_load_dwordx4 v[164:167], v253, s[12:15], s32 offen offset:0 sc1
    buffer_load_dwordx4 v[168:171], v253, s[12:15], s32 offen offset:1024 sc1
    buffer_load_dwordx4 v[172:175], v253, s[12:15], s32 offen offset:2048 sc1
    buffer_load_dwordx4 v[176:179], v253, s[12:15], s32 offen offset:3072 sc1
    s_add_u32 s32, s32, 4096
    buffer_load_dwordx4 v[180:183], v253, s[12:15], s32 offen offset:0 sc1
    buffer_load_dwordx4 v[184:187], v253, s[12:15], s32 offen offset:1024 sc1
    buffer_load_dwordx4 v[188:191], v253, s[12:15], s32 offen offset:2048 sc1
    buffer_load_dwordx4 v[192:195], v253, s[12:15], s32 offen offset:3072 sc1
    s_add_u32 s32, s32, 4096
    buffer_load_dwordx4 v[196:199], v253, s[12:15], s32 offen offset:0 sc1
    s_waitcnt lgkmcnt(0)
    ds_read_b128 v[48:51], v230 offset:0
    ds_read_b128 v[52:55], v230 offset:1024
    ds_read_b128 v[56:59], v230 offset:2048
    ds_read_b128 v[60:63], v230 offset:3072
    ds_read_b128 v[64:67], v230 offset:4096
    ds_read_b128 v[68:71], v230 offset:5120
    s_waitcnt vmcnt(12) lgkmcnt(3)
    v_mfma_f32_32x32x16_bf16 v[0:15], v[48:51], v[148:151], 0
    buffer_load_dwordx4 v[200:203], v253, s[12:15], s32 offen offset:1024 sc1
    v_mfma_f32_32x32x16_bf16 v[16:31], v[52:55], v[148:151], 0
    buffer_load_dwordx2 v[116:117], v234, s[12:15], s34 offen offset:0 sc1
    buffer_load_dwordx2 v[118:119], v234, s[12:15], s34 offen offset:256 sc1
    v_mfma_f32_32x32x16_bf16 v[32:47], v[148:151], v[56:59], 0
    ds_read_b128 v[72:75], v230 offset:6144
    ds_read_b128 v[76:79], v230 offset:7168
    ds_read_b128 v[80:83], v230 offset:8192
    s_waitcnt vmcnt(14) lgkmcnt(3)
    v_mfma_f32_32x32x16_bf16 v[0:15], v[60:63], v[152:155], v[0:15]
    buffer_load_dwordx4 v[204:207], v253, s[12:15], s32 offen offset:2048 sc1
    v_mfma_f32_32x32x16_bf16 v[16:31], v[64:67], v[152:155], v[16:31]
    buffer_load_dwordx2 v[120:121], v234, s[12:15], s34 offen offset:512 sc1
    buffer_load_dwordx2 v[122:123], v234, s[12:15], s34 offen offset:768 sc1
    v_mfma_f32_32x32x16_bf16 v[32:47], v[152:155], v[68:71], v[32:47]
    ds_read_b128 v[48:51], v230 offset:9216
    ds_read_b128 v[52:55], v230 offset:10240
    ds_read_b128 v[56:59], v230 offset:11264
    s_waitcnt vmcnt(16) lgkmcnt(3)
    v_mfma_f32_32x32x16_bf16 v[0:15], v[72:75], v[156:159], v[0:15]
    buffer_load_dwordx4 v[208:211], v253, s[12:15], s32 offen offset:3072 sc1
    s_add_u32 s32, s32, 4096
    v_mfma_f32_32x32x16_bf16 v[16:31], v[76:79], v[156:159], v[16:31]
    buffer_load_dwordx2 v[124:125], v234, s[12:15], s34 offen offset:1024 sc1
    buffer_load_dwordx2 v[126:127], v234, s[12:15], s34 offen offset:1280 sc1
    v_mfma_f32_32x32x16_bf16 v[32:47], v[156:159], v[80:83], v[32:47]
    ds_read_b128 v[60:63], v230 offset:12288
    ds_read_b128 v[64:67], v230 offset:13312
    ds_read_b128 v[68:71], v230 offset:14336
    s_waitcnt vmcnt(18) lgkmcnt(3)
    v_mfma_f32_32x32x16_bf16 v[0:15], v[48:51], v[160:163], v[0:15]
    buffer_load_dwordx4 v[212:215], v253, s[12:15], s32 offen offset:0 sc1
    v_mfma_f32_32x32x16_bf16 v[16:31], v[52:55], v[160:163], v[16:31]
    buffer_load_dwordx2 v[128:129], v234, s[12:15], s34 offen offset:1536 sc1
    buffer_load_dwordx2 v[130:131], v234, s[12:15], s34 offen offset:1792 sc1
    v_mfma_f32_32x32x16_bf16 v[32:47], v[160:163], v[56:59], v[32:47]
    ds_read_b128 v[72:75], v230 offset:15360
    ds_read_b128 v[76:79], v230 offset:16384
    ds_read_b128 v[80:83], v230 offset:17408
    s_waitcnt vmcnt(20) lgkmcnt(3)
    v_mfma_f32_32x32x16_bf16 v[0:15], v[60:63], v[164:167], v[0:15]
    buffer_load_dwordx4 v[216:219], v253, s[12:15], s32 offen offset:1024 sc1
    v_mfma_f32_32x32x16_bf16 v[16:31], v[64:67], v[164:167], v[16:31]
    v_mfma_f32_32x32x16_bf16 v[32:47], v[164:167], v[68:71], v[32:47]
    ds_read_b128 v[48:51], v230 offset:18432
    ds_read_b128 v[52:55], v230 offset:19456
    ds_read_b128 v[56:59], v230 offset:20480
    s_waitcnt vmcnt(20) lgkmcnt(3)
    v_mfma_f32_32x32x16_bf16 v[0:15], v[72:75], v[168:171], v[0:15]
    buffer_load_dwordx4 v[220:223], v253, s[12:15], s32 offen offset:2048 sc1
    v_mfma_f32_32x32x16_bf16 v[16:31], v[76:79], v[168:171], v[16:31]
    v_mfma_f32_32x32x16_bf16 v[32:47], v[168:171], v[80:83], v[32:47]
    ds_read_b128 v[60:63], v230 offset:21504
    ds_read_b128 v[64:67], v230 offset:22528
    ds_read_b128 v[68:71], v230 offset:23552
    s_waitcnt vmcnt(20) lgkmcnt(3)
    v_mfma_f32_32x32x16_bf16 v[0:15], v[48:51], v[172:175], v[0:15]
    buffer_load_dwordx4 v[224:227], v253, s[12:15], s32 offen offset:3072 sc1
    s_add_u32 s32, s32, 4096
    v_mfma_f32_32x32x16_bf16 v[16:31], v[52:55], v[172:175], v[16:31]
    v_mfma_f32_32x32x16_bf16 v[32:47], v[172:175], v[56:59], v[32:47]
    s_barrier
    ds_read_b128 v[72:75], v230 offset:24576
    ds_read_b128 v[76:79], v230 offset:25600
    ds_read_b128 v[80:83], v230 offset:26624
    s_waitcnt vmcnt(20) lgkmcnt(3)
    v_mfma_f32_32x32x16_bf16 v[0:15], v[60:63], v[176:179], v[0:15]
    buffer_load_dwordx4 v[148:151], v253, s[12:15], s32 offen offset:0 sc1
    v_mfma_f32_32x32x16_bf16 v[16:31], v[64:67], v[176:179], v[16:31]
    v_mfma_f32_32x32x16_bf16 v[32:47], v[176:179], v[68:71], v[32:47]
    ds_read_b128 v[48:51], v230 offset:27648
    ds_read_b128 v[52:55], v230 offset:28672
    ds_read_b128 v[56:59], v230 offset:29696
    s_waitcnt vmcnt(20) lgkmcnt(3)
    v_mfma_f32_32x32x16_bf16 v[0:15], v[72:75], v[180:183], v[0:15]
    buffer_load_dwordx4 v[152:155], v253, s[12:15], s32 offen offset:1024 sc1
    v_mfma_f32_32x32x16_bf16 v[16:31], v[76:79], v[180:183], v[16:31]
    v_mfma_f32_32x32x16_bf16 v[32:47], v[180:183], v[80:83], v[32:47]
    ds_read_b128 v[60:63], v230 offset:30720
    ds_read_b128 v[64:67], v230 offset:31744
    ds_read_b128 v[68:71], v230 offset:32768
    s_waitcnt vmcnt(20) lgkmcnt(3)
    v_mfma_f32_32x32x16_bf16 v[0:15], v[48:51], v[184:187], v[0:15]
    buffer_load_dwordx4 v[156:159], v253, s[12:15], s32 offen offset:2048 sc1
    v_mfma_f32_32x32x16_bf16 v[16:31], v[52:55], v[184:187], v[16:31]
    v_mfma_f32_32x32x16_bf16 v[32:47], v[184:187], v[56:59], v[32:47]
    ds_read_b128 v[72:75], v230 offset:33792
    ds_read_b128 v[76:79], v230 offset:34816
    ds_read_b128 v[80:83], v230 offset:35840
    s_waitcnt vmcnt(20) lgkmcnt(3)
    v_mfma_f32_32x32x16_bf16 v[0:15], v[60:63], v[188:191], v[0:15]
    buffer_load_dwordx4 v[160:163], v253, s[12:15], s32 offen offset:3072 sc1
    s_add_u32 s32, s32, 4096
    v_mfma_f32_32x32x16_bf16 v[16:31], v[64:67], v[188:191], v[16:31]
    v_mfma_f32_32x32x16_bf16 v[32:47], v[188:191], v[68:71], v[32:47]
    ds_read_b128 v[48:51], v230 offset:36864
    ds_read_b128 v[52:55], v230 offset:37888
    ds_read_b128 v[56:59], v230 offset:38912
    s_waitcnt vmcnt(20) lgkmcnt(3)
    v_mfma_f32_32x32x16_bf16 v[0:15], v[72:75], v[192:195], v[0:15]
    buffer_load_dwordx4 v[164:167], v253, s[12:15], s32 offen offset:0 sc1
    v_mfma_f32_32x32x16_bf16 v[16:31], v[76:79], v[192:195], v[16:31]
    v_mfma_f32_32x32x16_bf16 v[32:47], v[192:195], v[80:83], v[32:47]
    ds_read_b128 v[60:63], v230 offset:39936
    ds_read_b128 v[64:67], v230 offset:40960
    ds_read_b128 v[68:71], v230 offset:41984
    s_waitcnt vmcnt(20) lgkmcnt(3)
    v_mfma_f32_32x32x16_bf16 v[0:15], v[48:51], v[196:199], v[0:15]
    buffer_load_dwordx4 v[168:171], v253, s[12:15], s32 offen offset:1024 sc1
    v_mfma_f32_32x32x16_bf16 v[16:31], v[52:55], v[196:199], v[16:31]
    v_mfma_f32_32x32x16_bf16 v[32:47], v[196:199], v[56:59], v[32:47]
    ds_read_b128 v[72:75], v230 offset:43008
    ds_read_b128 v[76:79], v230 offset:44032
    ds_read_b128 v[80:83], v230 offset:45056
    s_waitcnt vmcnt(20) lgkmcnt(3)
    v_mfma_f32_32x32x16_bf16 v[0:15], v[60:63], v[200:203], v[0:15]
    buffer_load_dwordx4 v[172:175], v253, s[12:15], s32 offen offset:2048 sc1
    v_mfma_f32_32x32x16_bf16 v[16:31], v[64:67], v[200:203], v[16:31]
    v_mfma_f32_32x32x16_bf16 v[32:47], v[200:203], v[68:71], v[32:47]
    ds_read_b128 v[48:51], v230 offset:46080
    ds_read_b128 v[52:55], v230 offset:47104
    ds_read_b128 v[56:59], v230 offset:48128
    s_waitcnt vmcnt(10) lgkmcnt(3)
    v_mfma_f32_32x32x16_bf16 v[0:15], v[72:75], v[204:207], v[0:15]
    buffer_load_dwordx4 v[176:179], v253, s[12:15], s32 offen offset:3072 sc1
    s_add_u32 s32, s32, 4096
    v_mfma_f32_32x32x16_bf16 v[16:31], v[76:79], v[204:207], v[16:31]
    v_mfma_f32_32x32x16_bf16 v[32:47], v[204:207], v[80:83], v[32:47]
    v_add_f32 v116, v116, v118
    v_add_f32 v117, v117, v119
    v_add_f32 v120, v120, v122
    v_add_f32 v121, v121, v123
    v_add_f32 v116, v116, v120
    v_add_f32 v117, v117, v121
    v_add_f32 v124, v124, v126
    v_add_f32 v125, v125, v127
    v_add_f32 v128, v128, v130
    v_add_f32 v129, v129, v131
    v_add_f32 v124, v124, v128
    v_add_f32 v125, v125, v129
    v_cvt_f64_f32 v[140:141], v116
    v_cvt_f64_f32 v[142:143], v117
    v_cvt_f64_f32 v[144:145], v124
    v_cvt_f64_f32 v[146:147], v125
    v_add_f64 v[140:141], v[140:141], v[144:145]
    v_add_f64 v[142:143], v[142:143], v[146:147]
    v_mov_b32 v144, v140
    v_mov_b32 v145, v141
    v_mov_b32 v146, v142
    v_mov_b32 v147, v143
    s_nop 1
    v_permlane32_swap_b32 v140, v144
    v_permlane32_swap_b32 v141, v145
    v_permlane32_swap_b32 v142, v146
    v_permlane32_swap_b32 v143, v147
    s_nop 1
    v_add_f64 v[140:141], v[140:141], v[144:145]
    v_add_f64 v[142:143], v[142:143], v[146:147]
    v_ldexp_f64 v[140:141], v[140:141], -9
    v_ldexp_f64 v[142:143], v[142:143], -9
    v_fma_f64 v[142:143], -v[140:141], v[140:141], v[142:143]
    v_cvt_f32_f64 v248, v[140:141]
    v_cvt_f32_f64 v249, v[142:143]
    v_max_f32 v249, 0, v249
    v_add_f32 v249, 0x3727c5ac, v249
    v_rsq_f32 v249, v249
    s_nop 0
    v_mul_f32 v250, v248, v249
    v_sub_f32 v250, 0, v250
    v_mul_f32 v251, 0x3eb8aa3b, v249
    ds_write_b32 v236, v249
    ds_write_b32 v236, v250 offset:128
    v_mul_f32 v240, 0x3eb8aa3b, v250
    ds_read_b128 v[60:63], v231 offset:0
    ds_read_b128 v[64:67], v231 offset:1024
    ds_read_b128 v[68:71], v231 offset:2048
    s_waitcnt vmcnt(16) lgkmcnt(3)
    v_mfma_f32_32x32x16_bf16 v[0:15], v[48:51], v[208:211], v[0:15]
    buffer_load_dwordx4 v[180:183], v253, s[12:15], s32 offen offset:0 sc1
    v_mfma_f32_32x32x16_bf16 v[16:31], v[52:55], v[208:211], v[16:31]
    v_mfma_f32_32x32x16_bf16 v[32:47], v[208:211], v[56:59], v[32:47]
    ds_read_b128 v[72:75], v231 offset:3072
    ds_read_b128 v[76:79], v231 offset:4096
    ds_read_b128 v[80:83], v231 offset:5120
    s_waitcnt vmcnt(14) lgkmcnt(3)
    v_mfma_f32_32x32x16_bf16 v[0:15], v[60:63], v[212:215], v[0:15]
    buffer_load_dwordx4 v[184:187], v253, s[12:15], s32 offen offset:1024 sc1
    v_mfma_f32_32x32x16_bf16 v[16:31], v[64:67], v[212:215], v[16:31]
    v_mfma_f32_32x32x16_bf16 v[32:47], v[212:215], v[68:71], v[32:47]
    ds_read_b128 v[116:119], v237 offset:0
    ds_read_b128 v[132:135], v237 offset:128
    ds_read_b128 v[120:123], v237 offset:32
    ds_read_b128 v[136:139], v237 offset:160
    ds_read_b128 v[124:127], v237 offset:64
    ds_read_b128 v[140:143], v237 offset:192
    ds_read_b128 v[128:131], v237 offset:96
    ds_read_b128 v[144:147], v237 offset:224
    ds_read_b128 v[48:51], v231 offset:6144
    ds_read_b128 v[52:55], v231 offset:7168
    ds_read_b128 v[56:59], v231 offset:8192
    s_waitcnt vmcnt(12) lgkmcnt(3)
    v_mfma_f32_32x32x16_bf16 v[0:15], v[72:75], v[216:219], v[0:15]
    buffer_load_dwordx4 v[188:191], v253, s[12:15], s32 offen offset:2048 sc1
    v_mfma_f32_32x32x16_bf16 v[16:31], v[76:79], v[216:219], v[16:31]
    v_mfma_f32_32x32x16_bf16 v[32:47], v[216:219], v[80:83], v[32:47]
    ds_read_b128 v[60:63], v231 offset:9216
    ds_read_b128 v[64:67], v231 offset:10240
    ds_read_b128 v[68:71], v231 offset:11264
    s_waitcnt vmcnt(12) lgkmcnt(3)
    v_mfma_f32_32x32x16_bf16 v[0:15], v[48:51], v[220:223], v[0:15]
    buffer_load_dwordx4 v[192:195], v253, s[12:15], s32 offen offset:3072 sc1
    s_add_u32 s32, s32, 4096
    v_mfma_f32_32x32x16_bf16 v[16:31], v[52:55], v[220:223], v[16:31]
    v_mfma_f32_32x32x16_bf16 v[32:47], v[220:223], v[56:59], v[32:47]
    v_mul_f32 v84, v84, v240
    v_mul_f32 v85, v85, v240
    v_mul_f32 v86, v86, v240
    v_mul_f32 v87, v87, v240
    v_mul_f32 v88, v88, v240
    v_mul_f32 v89, v89, v240
    v_mul_f32 v90, v90, v240
    v_mul_f32 v91, v91, v240
    v_mul_f32 v92, v92, v240
    v_mul_f32 v93, v93, v240
    v_mul_f32 v94, v94, v240
    v_mul_f32 v95, v95, v240
    v_mul_f32 v96, v96, v240
    v_mul_f32 v97, v97, v240
    v_mul_f32 v98, v98, v240
    v_mul_f32 v99, v99, v240
    ds_read_b128 v[72:75], v231 offset:12288
    ds_read_b128 v[76:79], v231 offset:13312
    ds_read_b128 v[80:83], v231 offset:14336
    s_waitcnt vmcnt(12) lgkmcnt(3)
    v_mfma_f32_32x32x16_bf16 v[0:15], v[60:63], v[224:227], v[0:15]
    v_mfma_f32_32x32x16_bf16 v[16:31], v[64:67], v[224:227], v[16:31]
    v_mfma_f32_32x32x16_bf16 v[32:47], v[224:227], v[68:71], v[32:47]
    ds_read_b128 v[48:51], v231 offset:15360
    ds_read_b128 v[52:55], v231 offset:16384
    ds_read_b128 v[56:59], v231 offset:17408
    s_waitcnt vmcnt(11) lgkmcnt(3)
    v_mfma_f32_32x32x16_bf16 v[0:15], v[72:75], v[148:151], v[0:15]
    v_mfma_f32_32x32x16_bf16 v[16:31], v[76:79], v[148:151], v[16:31]
    v_mfma_f32_32x32x16_bf16 v[32:47], v[148:151], v[80:83], v[32:47]
    v_mul_f32 v100, v100, v250
    v_mul_f32 v101, v101, v250
    v_mul_f32 v102, v102, v250
    v_mul_f32 v103, v103, v250
    v_mul_f32 v104, v104, v250
    v_mul_f32 v105, v105, v250
    v_mul_f32 v106, v106, v250
    v_mul_f32 v107, v107, v250
    v_mul_f32 v108, v108, v250
    v_mul_f32 v109, v109, v250
    v_mul_f32 v110, v110, v250
    v_mul_f32 v111, v111, v250
    v_mul_f32 v112, v112, v250
    v_mul_f32 v113, v113, v250
    v_mul_f32 v114, v114, v250
    v_mul_f32 v115, v115, v250
    ds_read_b128 v[60:63], v231 offset:18432
    ds_read_b128 v[64:67], v231 offset:19456
    ds_read_b128 v[68:71], v231 offset:20480
    s_waitcnt vmcnt(10) lgkmcnt(3)
    v_mfma_f32_32x32x16_bf16 v[0:15], v[48:51], v[152:155], v[0:15]
    v_mfma_f32_32x32x16_bf16 v[16:31], v[52:55], v[152:155], v[16:31]
    v_mfma_f32_32x32x16_bf16 v[32:47], v[152:155], v[56:59], v[32:47]
    ds_read_b128 v[72:75], v231 offset:21504
    ds_read_b128 v[76:79], v231 offset:22528
    ds_read_b128 v[80:83], v231 offset:23552
    s_waitcnt vmcnt(9) lgkmcnt(3)
    v_mfma_f32_32x32x16_bf16 v[0:15], v[60:63], v[156:159], v[0:15]
    v_mfma_f32_32x32x16_bf16 v[16:31], v[64:67], v[156:159], v[16:31]
    v_mfma_f32_32x32x16_bf16 v[32:47], v[156:159], v[68:71], v[32:47]
    v_mul_f32 v132, v132, v241
    v_mul_f32 v133, v133, v241
    v_mul_f32 v134, v134, v241
    v_mul_f32 v135, v135, v241
    v_mul_f32 v136, v136, v241
    v_mul_f32 v137, v137, v241
    v_mul_f32 v138, v138, v241
    v_mul_f32 v139, v139, v241
    v_mul_f32 v140, v140, v241
    v_mul_f32 v141, v141, v241
    v_mul_f32 v142, v142, v241
    v_mul_f32 v143, v143, v241
    v_mul_f32 v144, v144, v241
    v_mul_f32 v145, v145, v241
    v_mul_f32 v146, v146, v241
    v_mul_f32 v147, v147, v241
    ds_read_b128 v[48:51], v231 offset:24576
    ds_read_b128 v[52:55], v231 offset:25600
    ds_read_b128 v[56:59], v231 offset:26624
    s_waitcnt vmcnt(8) lgkmcnt(3)
    v_mfma_f32_32x32x16_bf16 v[0:15], v[72:75], v[160:163], v[0:15]
    v_mfma_f32_32x32x16_bf16 v[16:31], v[76:79], v[160:163], v[16:31]
    v_mfma_f32_32x32x16_bf16 v[32:47], v[160:163], v[80:83], v[32:47]
    ds_read_b128 v[60:63], v231 offset:27648
    ds_read_b128 v[64:67], v231 offset:28672
    ds_read_b128 v[68:71], v231 offset:29696
    s_waitcnt vmcnt(7) lgkmcnt(3)
    v_mfma_f32_32x32x16_bf16 v[0:15], v[48:51], v[164:167], v[0:15]
    v_mfma_f32_32x32x16_bf16 v[16:31], v[52:55], v[164:167], v[16:31]
    v_mfma_f32_32x32x16_bf16 v[32:47], v[164:167], v[56:59], v[32:47]
    ds_read_b128 v[72:75], v231 offset:30720
    ds_read_b128 v[76:79], v231 offset:31744
    ds_read_b128 v[80:83], v231 offset:32768
    s_waitcnt vmcnt(6) lgkmcnt(3)
    v_mfma_f32_32x32x16_bf16 v[0:15], v[60:63], v[168:171], v[0:15]
    v_mfma_f32_32x32x16_bf16 v[16:31], v[64:67], v[168:171], v[16:31]
    v_mfma_f32_32x32x16_bf16 v[32:47], v[168:171], v[68:71], v[32:47]
    ds_read_b128 v[48:51], v231 offset:33792
    ds_read_b128 v[52:55], v231 offset:34816
    ds_read_b128 v[56:59], v231 offset:35840
    s_waitcnt vmcnt(5) lgkmcnt(3)
    v_mfma_f32_32x32x16_bf16 v[0:15], v[72:75], v[172:175], v[0:15]
    v_mfma_f32_32x32x16_bf16 v[16:31], v[76:79], v[172:175], v[16:31]
    v_mfma_f32_32x32x16_bf16 v[32:47], v[172:175], v[80:83], v[32:47]
    ds_read_b128 v[60:63], v231 offset:36864
    ds_read_b128 v[64:67], v231 offset:37888
    ds_read_b128 v[68:71], v231 offset:38912
    s_waitcnt vmcnt(4) lgkmcnt(3)
    v_mfma_f32_32x32x16_bf16 v[0:15], v[48:51], v[176:179], v[0:15]
    v_mfma_f32_32x32x16_bf16 v[16:31], v[52:55], v[176:179], v[16:31]
    v_mfma_f32_32x32x16_bf16 v[32:47], v[176:179], v[56:59], v[32:47]
    ds_read_b128 v[72:75], v231 offset:39936
    ds_read_b128 v[76:79], v231 offset:40960
    ds_read_b128 v[80:83], v231 offset:41984
    s_waitcnt vmcnt(3) lgkmcnt(3)
    v_mfma_f32_32x32x16_bf16 v[0:15], v[60:63], v[180:183], v[0:15]
    v_mfma_f32_32x32x16_bf16 v[16:31], v[64:67], v[180:183], v[16:31]
    v_mfma_f32_32x32x16_bf16 v[32:47], v[180:183], v[68:71], v[32:47]
    ds_read_b128 v[48:51], v231 offset:43008
    ds_read_b128 v[52:55], v231 offset:44032
    ds_read_b128 v[56:59], v231 offset:45056
    s_waitcnt vmcnt(2) lgkmcnt(3)
    v_mfma_f32_32x32x16_bf16 v[0:15], v[72:75], v[184:187], v[0:15]
    v_mfma_f32_32x32x16_bf16 v[16:31], v[76:79], v[184:187], v[16:31]
    v_mfma_f32_32x32x16_bf16 v[32:47], v[184:187], v[80:83], v[32:47]
    ds_read_b128 v[60:63], v231 offset:46080
    ds_read_b128 v[64:67], v231 offset:47104
    ds_read_b128 v[68:71], v231 offset:48128
    s_waitcnt vmcnt(1) lgkmcnt(3)
    v_mfma_f32_32x32x16_bf16 v[0:15], v[48:51], v[188:191], v[0:15]
    v_mfma_f32_32x32x16_bf16 v[16:31], v[52:55], v[188:191], v[16:31]
    v_mfma_f32_32x32x16_bf16 v[32:47], v[188:191], v[56:59], v[32:47]
    s_waitcnt vmcnt(0) lgkmcnt(0)
    v_mfma_f32_32x32x16_bf16 v[0:15], v[60:63], v[192:195], v[0:15]
    v_mfma_f32_32x32x16_bf16 v[16:31], v[64:67], v[192:195], v[16:31]
    v_mfma_f32_32x32x16_bf16 v[32:47], v[192:195], v[68:71], v[32:47]
    s_nop 7
    s_nop 2
    v_fma_f32 v16, v16, v249, v100
    v_fma_f32 v17, v17, v249, v101
    v_fma_f32 v18, v18, v249, v102
    v_fma_f32 v19, v19, v249, v103
    v_fma_f32 v20, v20, v249, v104
    v_fma_f32 v21, v21, v249, v105
    v_fma_f32 v22, v22, v249, v106
    v_fma_f32 v23, v23, v249, v107
    v_fma_f32 v24, v24, v249, v108
    v_fma_f32 v25, v25, v249, v109
    v_fma_f32 v26, v26, v249, v110
    v_fma_f32 v27, v27, v249, v111
    v_fma_f32 v28, v28, v249, v112
    v_fma_f32 v29, v29, v249, v113
    v_fma_f32 v30, v30, v249, v114
    v_fma_f32 v31, v31, v249, v115
    v_mul_f32 v244, v16, v16
    v_mul_f32 v245, v24, v24
    v_fmac_f32 v244, v17, v17
    v_fmac_f32 v245, v25, v25
    v_fmac_f32 v244, v18, v18
    v_fmac_f32 v245, v26, v26
    v_fmac_f32 v244, v19, v19
    v_fmac_f32 v245, v27, v27
    v_fmac_f32 v244, v20, v20
    v_fmac_f32 v245, v28, v28
    v_fmac_f32 v244, v21, v21
    v_fmac_f32 v245, v29, v29
    v_fmac_f32 v244, v22, v22
    v_fmac_f32 v245, v30, v30
    v_fmac_f32 v244, v23, v23
    v_fmac_f32 v245, v31, v31
    v_mov_b32 v246, v244
    v_mov_b32 v247, v245
    v_cvt_pk_bf16_f32 v148, v16, v17
    v_cvt_pk_bf16_f32 v149, v18, v19
    v_cvt_pk_bf16_f32 v150, v20, v21
    v_cvt_pk_bf16_f32 v151, v22, v23
    v_cvt_pk_bf16_f32 v152, v24, v25
    v_cvt_pk_bf16_f32 v153, v26, v27
    v_cvt_pk_bf16_f32 v154, v28, v29
    v_cvt_pk_bf16_f32 v155, v30, v31
    v_permlane32_swap_b32 v244, v246
    v_permlane32_swap_b32 v245, v247
    buffer_store_dwordx4 v[148:151], v253, s[12:15], s42 offen sc1
    buffer_store_dwordx4 v[152:155], v253, s[12:15], s43 offen sc1
    v_add_f32 v244, v244, v246
    v_add_f32 v245, v245, v247
    v_fma_f32 v0, v0, v251, v84
    v_fma_f32 v1, v1, v251, v85
    v_fma_f32 v2, v2, v251, v86
    v_fma_f32 v3, v3, v251, v87
    v_max_f32_dpp v244, v244, v244 quad_perm:[1,0,3,2] row_mask:0xf bank_mask:0xf
    v_max_f32_dpp v245, v245, v245 quad_perm:[1,0,3,2] row_mask:0xf bank_mask:0xf
    v_fma_f32 v4, v4, v251, v88
    v_fma_f32 v5, v5, v251, v89
    v_fma_f32 v6, v6, v251, v90
    v_fma_f32 v7, v7, v251, v91
    v_max_f32_dpp v244, v244, v244 quad_perm:[2,3,0,1] row_mask:0xf bank_mask:0xf
    v_max_f32_dpp v245, v245, v245 quad_perm:[2,3,0,1] row_mask:0xf bank_mask:0xf
    v_fma_f32 v8, v8, v251, v92
    v_fma_f32 v9, v9, v251, v93
    v_fma_f32 v10, v10, v251, v94
    v_fma_f32 v11, v11, v251, v95
    v_max_f32_dpp v244, v244, v244 row_half_mirror row_mask:0xf bank_mask:0xf
    v_max_f32_dpp v245, v245, v245 row_half_mirror row_mask:0xf bank_mask:0xf
    v_fma_f32 v12, v12, v251, v96
    v_fma_f32 v13, v13, v251, v97
    v_fma_f32 v14, v14, v251, v98
    v_fma_f32 v15, v15, v251, v99
    v_max_f32_dpp v244, v244, v244 row_mirror row_mask:0xf bank_mask:0xf
    v_max_f32_dpp v245, v245, v245 row_mirror row_mask:0xf bank_mask:0xf
    v_cvt_pk_bf16_f32 v156, v0, v1
    v_cvt_pk_bf16_f32 v157, v2, v3
    v_cvt_pk_bf16_f32 v158, v4, v5
    v_cvt_pk_bf16_f32 v159, v6, v7
    v_cvt_pk_bf16_f32 v160, v8, v9
    v_cvt_pk_bf16_f32 v161, v10, v11
    v_cvt_pk_bf16_f32 v162, v12, v13
    v_cvt_pk_bf16_f32 v163, v14, v15
    buffer_store_dwordx4 v[156:159], v253, s[12:15], s40 offen sc1
    buffer_store_dwordx4 v[160:163], v253, s[12:15], s41 offen sc1
    v_fma_f32 v32, v32, v116, v132
    v_fma_f32 v33, v33, v117, v133
    v_fma_f32 v34, v34, v118, v134
    v_fma_f32 v35, v35, v119, v135
    v_fma_f32 v36, v36, v120, v136
    v_fma_f32 v37, v37, v121, v137
    v_fma_f32 v38, v38, v122, v138
    v_fma_f32 v39, v39, v123, v139
    v_fma_f32 v40, v40, v124, v140
    v_fma_f32 v41, v41, v125, v141
    v_fma_f32 v42, v42, v126, v142
    v_fma_f32 v43, v43, v127, v143
    v_fma_f32 v44, v44, v128, v144
    v_fma_f32 v45, v45, v129, v145
    v_fma_f32 v46, v46, v130, v146
    v_fma_f32 v47, v47, v131, v147
    v_cvt_pk_bf16_f32 v164, v32, v33
    v_cvt_pk_bf16_f32 v165, v34, v35
    v_cvt_pk_bf16_f32 v166, v36, v37
    v_cvt_pk_bf16_f32 v167, v38, v39
    v_cvt_pk_bf16_f32 v168, v40, v41
    v_cvt_pk_bf16_f32 v169, v42, v43
    v_cvt_pk_bf16_f32 v170, v44, v45
    v_cvt_pk_bf16_f32 v171, v46, v47
    buffer_store_dwordx4 v[164:167], v242, s[12:15], s39 offen sc1
    buffer_store_dwordx4 v[168:171], v242, s[12:15], s39 offen offset:512 sc1
    s_mov_b64 exec, 0x10001
    buffer_store_dword v244, v243, s[12:15], s44 offen
    buffer_store_dword v245, v243, s[12:15], s44 offen offset:512
    s_branch blk1_kernel_end
blk1_kernel_nat:
    s_mov_b32 s20, s4
    s_and_b32 s21, s5, 0xffff
    s_mov_b32 s22, 2097152
    s_mov_b32 s23, 0x00020000
    s_lshl_b32 s58, s51, 7
    s_lshl_b32 s59, s53, 6
    s_add_u32 s58, s58, s59
    s_add_u32 s58, s58, s56
    v_and_b32 v64, 31, v252
    v_lshlrev_b32 v64, 10, v64
    v_lshrrev_b32 v65, 5, v252
    v_lshl_add_u32 v64, v65, 4, v64
    v_permlane32_swap_b32 v48, v50
    v_permlane32_swap_b32 v49, v51
    v_permlane32_swap_b32 v52, v54
    v_permlane32_swap_b32 v53, v55
    s_nop 1
    buffer_store_dwordx4 v[48:51], v64, s[20:23], s58 offen
    buffer_store_dwordx4 v[52:55], v64, s[20:23], s58 offen offset:32
blk1_kernel_end:
blk1_kernel_end_real:
    s_endpgm
.section .rodata,"a"
.p2align 6
.amdhsa_kernel qkv1_kernel
  .amdhsa_next_free_vgpr 256
  .amdhsa_next_free_sgpr 96
  .amdhsa_accum_offset 256
  .amdhsa_group_segment_fixed_size 0
  .amdhsa_kernarg_size 80
  .amdhsa_user_sgpr_count 2
  .amdhsa_user_sgpr_kernarg_segment_ptr 1
  .amdhsa_system_sgpr_workgroup_id_x 1
  .amdhsa_float_denorm_mode_32 3
.end_amdhsa_kernel
.p2align 6
.amdhsa_kernel attn1_kernel
  .amdhsa_next_free_vgpr 128
  .amdhsa_next_free_sgpr 96
  .amdhsa_accum_offset 128
  .amdhsa_group_segment_fixed_size 0
  .amdhsa_kernarg_size 80
  .amdhsa_user_sgpr_count 2
  .amdhsa_user_sgpr_kernarg_segment_ptr 1
  .amdhsa_system_sgpr_workgroup_id_x 1
  .amdhsa_float_denorm_mode_32 3
.end_amdhsa_kernel
.p2align 6
.amdhsa_kernel attn2_kernel
  .amdhsa_next_free_vgpr 128
  .amdhsa_next_free_sgpr 96
  .amdhsa_accum_offset 128
  .amdhsa_group_segment_fixed_size 0
  .amdhsa_kernarg_size 80
  .amdhsa_user_sgpr_count 2
  .amdhsa_user_sgpr_kernarg_segment_ptr 1
  .amdhsa_system_sgpr_workgroup_id_x 1
  .amdhsa_float_denorm_mode_32 3
.end_amdhsa_kernel
.p2align 6
.amdhsa_kernel blk1_kernel
  .amdhsa_next_free_vgpr 384
  .amdhsa_next_free_sgpr 96
  .amdhsa_accum_offset 256
  .amdhsa_group_segment_fixed_size 0
  .amdhsa_kernarg_size 80
  .amdhsa_user_sgpr_count 2
  .amdhsa_user_sgpr_kernarg_segment_ptr 1
  .amdhsa_system_sgpr_workgroup_id_x 1
  .amdhsa_float_denorm_mode_32 3
.end_amdhsa_kernel
.p2align 6
.amdhsa_kernel blk2_kernel
  .amdhsa_next_free_vgpr 384
  .amdhsa_next_free_sgpr 96
  .amdhsa_accum_offset 256
  .amdhsa_group_segment_fixed_size 0
  .amdhsa_kernarg_size 80
  .amdhsa_user_sgpr_count 2
  .amdhsa_user_sgpr_kernarg_segment_ptr 1
  .amdhsa_system_sgpr_workgroup_id_x 1
  .amdhsa_float_denorm_mode_32 3
.end_amdhsa_kernel
```
